```python
import torch

def _softmax(x, axis=-1):
    return torch.softmax(x, dim=axis)

def _gelu(x):
    return torch.nn.functional.gelu(x, approximate='tanh')

def _silu(x):
    return torch.nn.functional.silu(x)

def _sigmoid(x):
    return torch.sigmoid(x)

def _layernorm(x, axis=-1, eps=1e-05):
    m = x.mean(dim=axis, keepdim=True)
    v = x.var(dim=axis, keepdim=True, unbiased=False)
    return (x - m) / torch.sqrt(v + eps)

def _scatter_add(tgt, idx, src, axis=0):
    return tgt.clone().index_add_(axis, idx, src)

def _segment_sum(src, seg, n):
    out = torch.zeros((n,) + src.shape[1:], dtype=src.dtype)
    return out.index_add_(0, seg, src)

def _pad(x, pw):
    flat = tuple((v for pair in reversed(pw) for v in pair))
    return torch.nn.functional.pad(x, flat)
kernel_name = 'adaLN_cond__sliding_local_dilated__dense_activation_silu__prompt'

def setup_inputs():

    _w = lambda a: (lambda t: t.to(torch.bfloat16) if t.is_floating_point() else t)(torch.as_tensor(a))

    def _A_setup():
        B, S, D = (1, 2048, 512)
        return {'x': _w((lambda *s: torch.randn(*s, dtype=torch.bfloat16) * 0.05)(B, S, D)), 'wqkv': _w((lambda *s: torch.randn(*s, dtype=torch.bfloat16) * 0.05)(D, 3 * D)), 'wo': _w((lambda *s: torch.randn(*s, dtype=torch.bfloat16) * 0.05)(D, D))}
    _A_in = _A_setup()

    def _B_setup():
        B, S, D, F = (1, 2048, 512, 1376)
        return {'x': _w((lambda *s: torch.randn(*s, dtype=torch.bfloat16) * 0.05)(B, S, D)), 'w1': _w((lambda *s: torch.randn(*s, dtype=torch.bfloat16) * 3.2)(D, F) * D ** (-0.5)), 'w2': _w((lambda *s: torch.randn(*s, dtype=torch.bfloat16) * 0.4)(F, D) * F ** (-0.5))}
    _B_in = _B_setup()
    return {'A_x': _A_in['x'], 'A_wqkv': _A_in['wqkv'], 'A_wo': _A_in['wo'], 'B_x': _B_in['x'], 'B_w1': _B_in['w1'], 'B_w2': _B_in['w2'], 'c': _w((lambda *s: torch.randn(*s, dtype=torch.bfloat16) * 0.1)(1, 512) * 8.0), 'w_mod': _w((lambda *s: torch.randn(*s, dtype=torch.bfloat16) * 0.1)(512, 6 * 512) * 512 ** (-0.5) * 8.0)}

def reference(A_x, A_wqkv, A_wo, B_x, B_w1, B_w2, c, w_mod):

    def _A_ref(x, wqkv, wo):
        B, S, D = x.shape
        H = 32
        Dh = D // H
        W, dil = (8, 2)
        qkv = (lambda x, *d: x.permute(*d))((x @ wqkv).reshape(B, S, 3, H, Dh), 2, 0, 3, 1, 4)
        q, k, v = (qkv[0], qkv[1], qkv[2])
        scale = Dh ** (-0.5)
        pos = torch.arange(S)
        off = torch.arange(W) * dil
        idx = pos[:, None] - off[None, :]
        mask = idx >= 0
        idx_c = torch.where(mask, idx, 0).reshape(-1)
        kg = k[:, :, idx_c, :].reshape(B, H, S, W, Dh)
        vg = v[:, :, idx_c, :].reshape(B, H, S, W, Dh)
        logits = torch.einsum('bhsd,bhswd->bhsw', q, kg) * scale
        logits = torch.where(mask[None, None, :, :], logits, -1000000000.0)
        attn = _softmax(logits, axis=-1)
        o = torch.einsum('bhsw,bhswd->bhsd', attn, vg)
        return (lambda x, *d: x.permute(*d))(o, 0, 2, 1, 3).reshape(B, S, D) @ wo

    def _B_ref(x, w1, w2):
        h = torch.einsum('bsd,df->bsf', x, w1)
        h = _silu(h)
        out = torch.einsum('bsf,fd->bsd', h, w2)
        return out
    x = A_x
    mod = (_silu(c) @ w_mod).reshape(c.shape[0], 6, 1, -1)
    sa, ca, ga, sb, cb, gb = (mod[:, 0].clone(), mod[:, 1].clone(), mod[:, 2].clone(), mod[:, 3].clone(), mod[:, 4].clone(), mod[:, 5].clone())
    h = _layernorm(x, axis=-1) * (1 + ca) + sa
    x = x + ga * _A_ref(h, A_wqkv, A_wo)
    h = _layernorm(x, axis=-1) * (1 + cb) + sb
    x = x + gb * _B_ref(h, B_w1, B_w2)
    return x
```

```asm
; @launch grid=(256,1,1) block=(256,1,1) lds=163840
.amdgcn_target "amdgcn-amd-amdhsa--gfx950"
.text
.globl adaLN_cond__sliding_local_dilated__dense_activation_silu__prompt_kernel
.p2align 8
.type adaLN_cond__sliding_local_dilated__dense_activation_silu__prompt_kernel,@function
adaLN_cond__sliding_local_dilated__dense_activation_silu__prompt_kernel:
    s_cmp_ge_u32 s2, 256
    s_cbranch_scc1 L_end
    s_load_dwordx16 s[16:31], s[0:1], 0
    s_load_dwordx4 s[32:35], s[0:1], 64
    s_load_dwordx2 s[36:37], s[0:1], 80
    s_getreg_b32 s99, hwreg(HW_REG_XCC_ID, 0, 3)
    v_lshrrev_b32 v5, 6, v0
    v_and_b32 v1, 63, v0
    v_readfirstlane_b32 s3, v5
    v_and_b32 v2, 15, v0
    v_bfe_u32 v3, v0, 4, 2
    v_lshlrev_b32 v4, 4, v1
    s_and_b32 s55, s3, 1
    s_lshr_b32 s54, s3, 1
    s_cmp_eq_u32 s54, 1
    s_cselect_b64 s[56:57], -1, 0
    s_cmp_eq_u32 s3, 3
    s_cselect_b64 s[48:49], 0, -1
    s_cselect_b64 s[50:51], 1, 0
    s_cselect_b64 s[100:101], -1, 0
    s_mov_b32 s39, 0
    s_getpc_b64 s[58:59]
L_pc:
    s_lshr_b32 s60, s2, 3
    s_and_b32 s60, s60, 15
    s_lshl_b32 s60, s60, 12
    v_lshlrev_b32 v5, 4, v0
    v_add_u32 v5, s60, v5
    v_min_u32 v5, L_code_end-L_pc-16, v5
    global_load_dwordx4 v[252:255], v5, s[58:59]
    s_waitcnt lgkmcnt(0)
    s_mov_b32 s12, s30
    s_and_b32 s13, s31, 0xffff
    s_mov_b32 s14, 0x300000
    s_mov_b32 s15, 0x00020000
    s_mov_b32 s8, s16
    s_and_b32 s9, s17, 0xffff
    s_mov_b32 s10, 0x200000
    s_mov_b32 s11, 0x00020000
    s_mov_b32 s40, s18
    s_and_b32 s41, s19, 0xffff
    s_mov_b32 s42, 0x180000
    s_mov_b32 s43, 0x00020000
    s_mov_b32 s44, s28
    s_and_b32 s45, s29, 0xffff
    s_mov_b32 s46, 0x400
    s_mov_b32 s47, 0x00020000
    s_and_b32 s58, s2, 7
    s_lshl_b32 s58, s58, 5
    s_lshr_b32 s0, s2, 3
    s_or_b32 s0, s0, s58
    s_lshr_b32 s52, s0, 3
    s_and_b32 s53, s0, 7
    s_lshr_b32 s58, s0, 5
    s_and_b32 s59, s0, 31
    s_lshr_b32 s60, s59, 2
    s_lshl_b32 s60, s60, 3
    s_add_u32 s60, s60, s58
    s_lshl_b32 s60, s60, 2
    s_and_b32 s58, s59, 3
    s_add_u32 s78, s60, s58
    s_cmp_lt_u32 s59, 8
    s_cselect_b32 s79, 1, 0
    s_cselect_b32 s78, s78, 0
    v_lshrrev_b32 v5, 1, v0
    v_lshlrev_b32 v7, 1, v5
    s_movk_i32 s58, 6144
    v_mul_lo_u32 v62, v5, s58
    v_and_b32 v5, 1, v0
    v_lshl_add_u32 v62, v5, 4, v62
    buffer_load_ushort v8, v7, s[44:47], 0 offen offset:0
    buffer_load_ushort v9, v7, s[44:47], 0 offen offset:256
    buffer_load_ushort v10, v7, s[44:47], 0 offen offset:512
    buffer_load_ushort v11, v7, s[44:47], 0 offen offset:768
    v_lshrrev_b32 v56, 3, v1
    s_lshl_b32 s58, s52, 6
    s_mul_i32 s59, s53, 10
    s_add_u32 s58, s58, s59
    s_mul_i32 s59, s3, 5
    s_add_u32 s58, s58, s59
    s_sub_u32 s58, s58, 21
    v_add_u32 v56, s58, v56
    v_max_i32 v56, 0, v56
    v_and_b32 v57, 7, v1
    v_lshlrev_b32 v57, 7, v57
    v_lshl_add_u32 v56, v56, 10, v57
    s_mov_b32 m0, 161792
    s_xor_b32 s59, s54, s55
    s_cmp_eq_u32 s59, 1
    s_cselect_b32 exec_lo, -1, 0
    s_cselect_b32 exec_hi, 0xff, 0
    buffer_load_dword v56, s[8:11], 0 offen lds
    s_mov_b64 exec, -1
    s_and_b32 s58, s0, 31
    s_lshl_b32 s58, s58, 4
    v_add_u32 v56, s58, v2
    v_mul_u32_u24 v56, 6144, v56
    v_lshl_add_u32 v56, v3, 10, v56
    s_lshr_b32 s58, s0, 5
    s_lshl_b32 s58, s58, 7
    s_mov_b32 m0, 161792
    s_cmp_eq_u32 s3, 0
    s_cselect_b32 exec_lo, -1, 0
    s_cselect_b32 exec_hi, 0, 0
    buffer_load_dword v56, s[12:15], s58 offen lds
    s_mov_b64 exec, -1
    s_mov_b32 s4, s36
    s_and_b32 s5, s37, 0xffff
    s_mov_b32 s6, 0x1100000
    s_mov_b32 s7, 0x00020000
    s_load_dword s23, s[36:37], 0
    s_lshl_b32 s58, s52, 6
    v_lshrrev_b32 v12, 2, v1
    v_and_b32 v13, 3, v1
    v_add_u32 v5, s58, v12
    v_subrev_u32 v32, 16, v5
    v_max_i32 v32, 0, v32
    s_lshl_b32 s59, s3, 8
    v_lshl_add_u32 v33, v13, 4, s59
    v_lshl_add_u32 v5, v5, 10, v33
    v_lshl_add_u32 v32, v32, 10, v33
    s_bfe_u32 s1, s52, 0x20002
    s_add_u32 s16, s1, 0
    s_and_b32 s16, s16, 3
    s_lshl_b32 s16, s16, 6
    s_add_u32 s17, s1, 1
    s_and_b32 s17, s17, 3
    s_lshl_b32 s17, s17, 6
    s_add_u32 s18, s1, 2
    s_and_b32 s18, s18, 3
    s_lshl_b32 s18, s18, 6
    s_add_u32 s19, s1, 3
    s_and_b32 s19, s19, 3
    s_lshl_b32 s19, s19, 6
    buffer_load_dwordx4 v[64:67], v32, s[8:11], s16 offen
    buffer_load_dwordx4 v[68:71], v32, s[8:11], s17 offen
    buffer_load_dwordx4 v[72:75], v32, s[8:11], s18 offen
    buffer_load_dwordx4 v[76:79], v32, s[8:11], s19 offen
    buffer_load_dwordx4 v[80:83], v5, s[8:11], s16 offen
    buffer_load_dwordx4 v[84:87], v5, s[8:11], s17 offen
    buffer_load_dwordx4 v[88:91], v5, s[8:11], s18 offen
    buffer_load_dwordx4 v[92:95], v5, s[8:11], s19 offen
    s_add_u32 s58, s16, 0x4000
    buffer_load_dwordx4 v[96:99], v5, s[8:11], s58 offen
    s_add_u32 s58, s17, 0x4000
    buffer_load_dwordx4 v[100:103], v5, s[8:11], s58 offen
    s_add_u32 s58, s18, 0x4000
    buffer_load_dwordx4 v[104:107], v5, s[8:11], s58 offen
    s_add_u32 s58, s19, 0x4000
    buffer_load_dwordx4 v[108:111], v5, s[8:11], s58 offen
    s_add_u32 s58, s16, 0x8000
    buffer_load_dwordx4 v[112:115], v5, s[8:11], s58 offen
    s_add_u32 s58, s17, 0x8000
    buffer_load_dwordx4 v[116:119], v5, s[8:11], s58 offen
    s_add_u32 s58, s18, 0x8000
    buffer_load_dwordx4 v[120:123], v5, s[8:11], s58 offen
    s_add_u32 s58, s19, 0x8000
    buffer_load_dwordx4 v[124:127], v5, s[8:11], s58 offen
    s_add_u32 s58, s16, 0xc000
    buffer_load_dwordx4 v[128:131], v5, s[8:11], s58 offen
    s_add_u32 s58, s17, 0xc000
    buffer_load_dwordx4 v[132:135], v5, s[8:11], s58 offen
    s_add_u32 s58, s18, 0xc000
    buffer_load_dwordx4 v[136:139], v5, s[8:11], s58 offen
    s_add_u32 s58, s19, 0xc000
    buffer_load_dwordx4 v[140:143], v5, s[8:11], s58 offen
    s_cmp_eq_u32 s79, 1
    s_cselect_b64 exec, -1, 0
    s_lshl_b32 s58, s78, 5
    buffer_load_dwordx4 v[16:19], v62, s[12:15], s58 offen
    s_add_u32 s58, s58, 0xc0000
    buffer_load_dwordx4 v[20:23], v62, s[12:15], s58 offen
    s_add_u32 s58, s58, 0xc0000
    buffer_load_dwordx4 v[24:27], v62, s[12:15], s58 offen
    s_add_u32 s58, s58, 0xc0000
    buffer_load_dwordx4 v[28:31], v62, s[12:15], s58 offen
    s_mov_b64 exec, -1
    v_lshrrev_b32 v5, 3, v1
    v_mul_u32_u24 v5, 3072, v5
    v_and_b32 v34, 7, v1
    v_bfe_u32 v35, v1, 4, 1
    v_lshlrev_b32 v35, 1, v35
    v_xor_b32 v34, v34, v35
    s_lshl_b32 s58, s55, 2
    v_xor_b32 v34, s58, v34
    v_lshl_add_u32 v6, v34, 4, v5
    s_mul_i32 s70, s3, 24576
    s_lshl_b32 s58, s53, 7
    s_add_u32 s70, s70, s58
    s_mul_i32 s71, s3, 3072
    s_lshl_b32 s22, s3, 12
    s_mul_i32 s16, s16, 1536
    s_add_u32 s16, s16, s70
    s_mul_i32 s17, s17, 1536
    s_add_u32 s17, s17, s70
    s_mul_i32 s18, s18, 1536
    s_add_u32 s18, s18, s70
    s_mul_i32 s19, s19, 1536
    s_add_u32 s19, s19, s70
    s_add_u32 m0, s71, 0x14000
    s_add_u32 s58, s16, 0x0
    buffer_load_dwordx4 v6, s[40:43], s58 offen offset:0 lds
    buffer_load_dwordx4 v6, s[40:43], s58 offen offset:1024 lds
    buffer_load_dwordx4 v6, s[40:43], s58 offen offset:2048 lds
    s_add_u32 m0, s71, 0x17000
    s_add_u32 s58, s16, 0x60000
    buffer_load_dwordx4 v6, s[40:43], s58 offen offset:0 lds
    buffer_load_dwordx4 v6, s[40:43], s58 offen offset:1024 lds
    buffer_load_dwordx4 v6, s[40:43], s58 offen offset:2048 lds
    s_movk_i32 s59, 3072
    v_bfe_u32 v34, v1, 2, 2
    v_lshlrev_b32 v14, 7, v34
    v_mad_u32_u24 v14, v3, s59, v14
    v_lshrrev_b32 v34, 1, v34
    v_lshlrev_b32 v34, 1, v34
    v_and_b32 v35, 1, v3
    v_lshl_or_b32 v34, v35, 2, v34
    s_lshl_b32 s58, s3, 1
    v_xor_b32 v34, s58, v34
    v_lshl_add_u32 v14, v34, 4, v14
    v_lshl_add_u32 v14, v13, 3, v14
    v_lshl_add_u32 v57, v3, 10, v14
    v_add_u32 v57, 16384, v57
    v_add_u32 v15, 131072, v14
    v_add_u32 v14, 65536, v14
    s_lshl_b32 s62, s2, 2
    s_add_u32 s62, s62, s3
    s_sub_u32 s62, s62, 256
    s_cmp_lt_u32 s62, 696
    s_cselect_b32 s77, 1, 0
    s_min_u32 s62, s62, 695
    s_add_u32 s62, s62, 128
    s_cmp_ge_u32 s62, 128
    s_cselect_b32 s64, 1, 0
    s_cmp_ge_u32 s62, 480
    s_cselect_b32 s64, 2, s64
    s_sub_u32 s65, s62, 128
    s_cmp_eq_u32 s64, 1
    s_cselect_b32 s66, s65, s62
    s_sub_u32 s65, s62, 480
    s_cmp_eq_u32 s64, 2
    s_cselect_b32 s66, s65, s66
    s_and_b32 s67, s66, 15
    s_lshr_b32 s68, s66, 4
    s_lshr_b32 s59, s66, 3
    s_and_b32 s60, s66, 7
    s_cmp_eq_u32 s64, 2
    s_cselect_b32 s67, s59, s67
    s_cselect_b32 s68, s60, s68
    s_cselect_b32 s75, 43, 16
    s_lshl_b32 s75, s75, 10
    s_mov_b32 s72, 1024
    s_mov_b32 s44, s20
    s_mov_b32 s45, s21
    s_mov_b32 s46, 0x80000
    s_mov_b32 s61, 0x280000
    s_mov_b32 s76, 16
    s_cmp_eq_u32 s64, 1
    s_cselect_b32 s72, 0xac0, s72
    s_cselect_b32 s44, s24, s44
    s_cselect_b32 s45, s25, s45
    s_cselect_b32 s46, 0x158000, s46
    s_cselect_b32 s61, 0x300000, s61
    s_cselect_b32 s76, 8, s76
    s_cmp_eq_u32 s64, 2
    s_cselect_b32 s72, 0x400, s72
    s_cselect_b32 s44, s26, s44
    s_cselect_b32 s45, s27, s45
    s_cselect_b32 s46, 0x158000, s46
    s_cselect_b32 s61, 0x480000, s61
    s_cselect_b32 s76, 16, s76
    s_and_b32 s45, s45, 0xffff
    s_mov_b32 s47, 0x00020000
    s_mul_i32 s73, s67, s72
    s_lshl_b32 s73, s73, 5
    s_lshl_b32 s65, s68, 7
    s_add_u32 s73, s73, s65
    s_mul_i32 s74, s68, s75
    s_lshl_b32 s74, s74, 2
    s_lshl_b32 s65, s67, 10
    s_add_u32 s74, s74, s65
    s_add_u32 s74, s74, s61
    s_cmp_eq_u32 s77, 1
    s_cselect_b32 s46, s46, 0
    s_cselect_b32 s74, s74, 0x1100000
    s_cmp_eq_u32 s79, 1
    s_cbranch_scc0 L_noearly_1
    s_mov_b32 s58, 0xbfb8aa3b
    s_waitcnt vmcnt(35)
    v_lshlrev_b32 v52, 16, v8
    s_waitcnt vmcnt(34)
    v_lshlrev_b32 v53, 16, v9
    s_waitcnt vmcnt(33)
    v_lshlrev_b32 v54, 16, v10
    s_waitcnt vmcnt(32)
    v_lshlrev_b32 v55, 16, v11
    v_mul_f32 v36, s58, v52
    v_mul_f32 v37, s58, v53
    v_mul_f32 v38, s58, v54
    v_mul_f32 v39, s58, v55
    v_exp_f32 v36, v36
    v_exp_f32 v37, v37
    v_exp_f32 v38, v38
    v_exp_f32 v39, v39
    v_add_f32 v36, 1.0, v36
    v_add_f32 v37, 1.0, v37
    v_add_f32 v38, 1.0, v38
    v_add_f32 v39, 1.0, v39
    v_rcp_f32 v36, v36
    v_rcp_f32 v37, v37
    v_rcp_f32 v38, v38
    v_rcp_f32 v39, v39
    v_mul_f32 v52, v52, v36
    v_mul_f32 v53, v53, v37
    v_mul_f32 v54, v54, v38
    v_mul_f32 v55, v55, v39
    v_cvt_pk_bf16_f32 v52, v52, v52
    v_cvt_pk_bf16_f32 v53, v53, v53
    v_cvt_pk_bf16_f32 v54, v54, v54
    v_cvt_pk_bf16_f32 v55, v55, v55
    v_and_b32 v52, 0xffff0000, v52
    v_and_b32 v53, 0xffff0000, v53
    v_and_b32 v54, 0xffff0000, v54
    v_and_b32 v55, 0xffff0000, v55
    s_waitcnt lgkmcnt(0)
    s_add_u32 s38, s23, 0x9e3779b8
    v_lshrrev_b32 v44, 16, v52
    v_lshrrev_b32 v45, 16, v53
    v_lshrrev_b32 v46, 16, v54
    v_lshrrev_b32 v47, 16, v55
    s_waitcnt vmcnt(9)
    v_dot2_f32_bf16 v36, v16, v44, 0
    v_dot2_f32_bf16 v37, v16, v52, 0
    v_dot2_f32_bf16 v38, v17, v44, 0
    v_dot2_f32_bf16 v39, v17, v52, 0
    v_dot2_f32_bf16 v40, v18, v44, 0
    v_dot2_f32_bf16 v41, v18, v52, 0
    v_dot2_f32_bf16 v42, v19, v44, 0
    v_dot2_f32_bf16 v43, v19, v52, 0
    s_waitcnt vmcnt(8)
    v_dot2_f32_bf16 v36, v20, v45, v36
    v_dot2_f32_bf16 v37, v20, v53, v37
    v_dot2_f32_bf16 v38, v21, v45, v38
    v_dot2_f32_bf16 v39, v21, v53, v39
    v_dot2_f32_bf16 v40, v22, v45, v40
    v_dot2_f32_bf16 v41, v22, v53, v41
    v_dot2_f32_bf16 v42, v23, v45, v42
    v_dot2_f32_bf16 v43, v23, v53, v43
    s_waitcnt vmcnt(7)
    v_dot2_f32_bf16 v36, v24, v46, v36
    v_dot2_f32_bf16 v37, v24, v54, v37
    v_dot2_f32_bf16 v38, v25, v46, v38
    v_dot2_f32_bf16 v39, v25, v54, v39
    v_dot2_f32_bf16 v40, v26, v46, v40
    v_dot2_f32_bf16 v41, v26, v54, v41
    v_dot2_f32_bf16 v42, v27, v46, v42
    v_dot2_f32_bf16 v43, v27, v54, v43
    s_waitcnt vmcnt(6)
    v_dot2_f32_bf16 v36, v28, v47, v36
    v_dot2_f32_bf16 v37, v28, v55, v37
    v_dot2_f32_bf16 v38, v29, v47, v38
    v_dot2_f32_bf16 v39, v29, v55, v39
    v_dot2_f32_bf16 v40, v30, v47, v40
    v_dot2_f32_bf16 v41, v30, v55, v41
    v_dot2_f32_bf16 v42, v31, v47, v42
    v_dot2_f32_bf16 v43, v31, v55, v43
    v_add_f32_dpp v36, v36, v36 row_shr:2 row_mask:0xf bank_mask:0xf bound_ctrl:0
    v_add_f32_dpp v37, v37, v37 row_shr:2 row_mask:0xf bank_mask:0xf bound_ctrl:0
    v_add_f32_dpp v38, v38, v38 row_shr:2 row_mask:0xf bank_mask:0xf bound_ctrl:0
    v_add_f32_dpp v39, v39, v39 row_shr:2 row_mask:0xf bank_mask:0xf bound_ctrl:0
    v_add_f32_dpp v40, v40, v40 row_shr:2 row_mask:0xf bank_mask:0xf bound_ctrl:0
    v_add_f32_dpp v41, v41, v41 row_shr:2 row_mask:0xf bank_mask:0xf bound_ctrl:0
    v_add_f32_dpp v42, v42, v42 row_shr:2 row_mask:0xf bank_mask:0xf bound_ctrl:0
    v_add_f32_dpp v43, v43, v43 row_shr:2 row_mask:0xf bank_mask:0xf bound_ctrl:0
    v_add_f32_dpp v36, v36, v36 row_shr:4 row_mask:0xf bank_mask:0xf bound_ctrl:0
    v_add_f32_dpp v37, v37, v37 row_shr:4 row_mask:0xf bank_mask:0xf bound_ctrl:0
    v_add_f32_dpp v38, v38, v38 row_shr:4 row_mask:0xf bank_mask:0xf bound_ctrl:0
    v_add_f32_dpp v39, v39, v39 row_shr:4 row_mask:0xf bank_mask:0xf bound_ctrl:0
    v_add_f32_dpp v40, v40, v40 row_shr:4 row_mask:0xf bank_mask:0xf bound_ctrl:0
    v_add_f32_dpp v41, v41, v41 row_shr:4 row_mask:0xf bank_mask:0xf bound_ctrl:0
    v_add_f32_dpp v42, v42, v42 row_shr:4 row_mask:0xf bank_mask:0xf bound_ctrl:0
    v_add_f32_dpp v43, v43, v43 row_shr:4 row_mask:0xf bank_mask:0xf bound_ctrl:0
    v_add_f32_dpp v36, v36, v36 row_shr:8 row_mask:0xf bank_mask:0xf bound_ctrl:0
    v_add_f32_dpp v37, v37, v37 row_shr:8 row_mask:0xf bank_mask:0xf bound_ctrl:0
    v_add_f32_dpp v38, v38, v38 row_shr:8 row_mask:0xf bank_mask:0xf bound_ctrl:0
    v_add_f32_dpp v39, v39, v39 row_shr:8 row_mask:0xf bank_mask:0xf bound_ctrl:0
    v_add_f32_dpp v40, v40, v40 row_shr:8 row_mask:0xf bank_mask:0xf bound_ctrl:0
    v_add_f32_dpp v41, v41, v41 row_shr:8 row_mask:0xf bank_mask:0xf bound_ctrl:0
    v_add_f32_dpp v42, v42, v42 row_shr:8 row_mask:0xf bank_mask:0xf bound_ctrl:0
    v_add_f32_dpp v43, v43, v43 row_shr:8 row_mask:0xf bank_mask:0xf bound_ctrl:0
    s_lshl_b32 s58, s3, 8
    s_add_u32 s58, s58, 5120
    v_lshl_add_u32 v32, v3, 6, s58
    v_and_b32 v33, 1, v1
    v_lshl_add_u32 v32, v33, 5, v32
    s_mov_b32 s58, 0xc000c000
    s_mov_b32 s59, 0xc000c000
    s_mov_b64 exec, s[58:59]
    ds_write_b128 v32, v[36:39]
    ds_write_b128 v32, v[40:43] offset:16
    s_mov_b64 exec, -1
    v_lshlrev_b32 v32, 2, v2
    v_lshl_add_u32 v32, v3, 8, v32
    v_add_u32 v32, 5120, v32
    s_lshr_b32 s58, s78, 5
    s_cmp_eq_u32 s58, 1
    s_cselect_b32 s59, 1.0, 0
    s_cmp_eq_u32 s58, 4
    s_cselect_b32 s59, 1.0, s59
    s_lshl_b32 s58, s78, 6
    s_add_u32 s58, s58, 0x4000
    s_cmp_eq_u32 s79, 1
    s_cselect_b32 s60, 0x5555, 0
    s_mov_b32 s61, 0
    v_lshlrev_b32 v33, 2, v2
    s_waitcnt lgkmcnt(0)
    s_barrier
    s_cmp_eq_u32 s3, 3
    s_cbranch_scc0 L_w3_2
    v_mov_b32 v47, s38
    ds_read2_b32 v[34:35], v32 offset0:0 offset1:16
    ds_read2_b32 v[38:39], v32 offset0:32 offset1:48
    s_waitcnt lgkmcnt(1)
    v_add_f32 v34, v34, v35
    s_waitcnt lgkmcnt(0)
    v_add_f32 v38, v38, v39
    v_add_f32 v34, v34, v38
    v_mov_b32 v35, v34
    s_nop 1
    v_permlane32_swap_b32 v35, v34
    v_add_f32 v34, v34, v35
    v_mov_b32 v35, v34
    s_nop 1
    v_permlane16_swap_b32 v35, v34
    v_add_f32 v34, v34, v35
    v_cvt_pk_bf16_f32 v34, v34, v34
    v_and_b32 v34, 0xffff0000, v34
    v_add_f32 v34, s59, v34
    s_nop 1
    v_mov_b32_dpp v35, v34 quad_perm:[1,0,3,2] row_mask:0xf bank_mask:0xf
    v_cvt_pk_bf16_f32 v46, v34, v35
    s_waitcnt lgkmcnt(0)
    s_nop 1
L_w3_2:
    s_and_b64 exec, s[60:61], s[100:101]
    buffer_store_dwordx2 v[46:47], v33, s[4:7], s58 offen sc1
    s_mov_b64 exec, -1
L_noearly_1:
    s_mov_b32 s58, 0xbfb8aa3b
    s_waitcnt vmcnt(35)
    v_lshlrev_b32 v8, 16, v8
    s_waitcnt vmcnt(34)
    v_lshlrev_b32 v9, 16, v9
    s_waitcnt vmcnt(33)
    v_lshlrev_b32 v10, 16, v10
    s_waitcnt vmcnt(32)
    v_lshlrev_b32 v11, 16, v11
    v_mul_f32 v32, s58, v8
    v_mul_f32 v33, s58, v9
    v_mul_f32 v34, s58, v10
    v_mul_f32 v35, s58, v11
    v_exp_f32 v32, v32
    v_exp_f32 v33, v33
    v_exp_f32 v34, v34
    v_exp_f32 v35, v35
    v_add_f32 v32, 1.0, v32
    v_add_f32 v33, 1.0, v33
    v_add_f32 v34, 1.0, v34
    v_add_f32 v35, 1.0, v35
    v_rcp_f32 v32, v32
    v_rcp_f32 v33, v33
    v_rcp_f32 v34, v34
    v_rcp_f32 v35, v35
    v_mul_f32 v8, v8, v32
    v_mul_f32 v9, v9, v33
    v_mul_f32 v10, v10, v34
    v_mul_f32 v11, v11, v35
    v_cvt_pk_bf16_f32 v8, v8, v8
    v_cvt_pk_bf16_f32 v9, v9, v9
    v_cvt_pk_bf16_f32 v10, v10, v10
    v_cvt_pk_bf16_f32 v11, v11, v11
    v_and_b32 v8, 0xffff0000, v8
    v_and_b32 v9, 0xffff0000, v9
    v_and_b32 v10, 0xffff0000, v10
    v_and_b32 v11, 0xffff0000, v11
    s_waitcnt lgkmcnt(0)
    s_add_u32 s38, s23, 0x9e3779b8
    s_xor_b32 s99, s99, s38
    s_lshl_b32 s58, s52, 7
    s_lshl_b32 s59, s53, 2
    s_add_u32 s58, s58, s59
    s_add_u32 s58, s58, 0x1020
    v_mov_b32 v60, s99
    v_mov_b32 v63, 0
    s_mov_b64 exec, s[50:51]
    buffer_store_dword v60, v63, s[4:7], s58 offen sc1
    s_mov_b64 exec, -1
    v_mov_b32 v27, v57
    v_lshlrev_b32 v32, 5, v12
    s_lshl_b32 s58, s3, 3
    v_add_u32 v33, s58, v32
    s_lshl_b32 s58, s3, 9
    s_add_u32 s58, s58, 155648
    v_lshl_add_u32 v5, v13, 5, s58
    v_lshrrev_b32 v58, 1, v12
    v_xor_b32 v58, v58, v13
    v_and_b32 v58, 3, v58
    v_lshlrev_b32 v12, 6, v12
    v_lshl_add_u32 v12, v58, 4, v12
    s_lshl_b32 s58, s3, 12
    v_add_u32 v12, s58, v12
    v_add_u32 v13, 49152, v12
    v_lshrrev_b32 v58, 1, v2
    v_xor_b32 v58, v58, v3
    v_and_b32 v58, 3, v58
    v_lshlrev_b32 v56, 6, v2
    v_lshl_add_u32 v56, v58, 4, v56
    v_add_u32 v57, 49152, v56
    v_and_b32 v58, 1, v2
    v_cmp_eq_u32 s[90:91], 1, v58
    v_lshl_add_u32 v59, v3, 2, v58
    v_cmp_le_u32 s[92:93], v59, v2
    v_add_u32 v59, 2, v59
    v_cmp_le_u32 s[94:95], v59, v2
    v_mov_b32 v58, 0xffff
    v_mov_b32 v59, 0xffff0000
    v_cndmask_b32 v58, v58, v59, s[90:91]
    v_cndmask_b32 v60, 0, v58, s[92:93]
    v_cndmask_b32 v61, v58, 0, s[92:93]
    v_cndmask_b32 v63, 0, v58, s[94:95]
    v_cndmask_b32 v59, v58, 0, s[94:95]
    v_lshrrev_b32 v58, 5, v1
    v_lshlrev_b32 v58, 11, v58
    s_lshl_b32 s58, s3, 9
    v_add_u32 v58, s58, v58
    v_and_b32 v36, 0x1f0, v4
    v_add_u32 v36, v58, v36
    v_lshrrev_b32 v37, 3, v1
    v_subrev_u32 v37, s1, v37
    v_and_b32 v37, 3, v37
    v_lshl_add_u32 v58, v37, 7, v58
    v_and_b32 v37, 0x70, v4
    v_add_u32 v58, 155648, v58
    v_add_u32 v37, v58, v37
    s_lshl_b32 s97, s53, 2
    s_add_u32 s97, s97, s3
    s_mul_i32 s97, s97, 86
    s_lshr_b32 s97, s97, 5
    s_lshl_b32 s96, s97, 14
    s_add_u32 s96, s96, 0x300000
    s_mov_b32 s69, 0x3f803f80
    s_waitcnt vmcnt(30)
    v_dot2_f32_bf16 v40, v64, s69, 0
    v_dot2_f32_bf16 v41, v64, v64, 0
    s_waitcnt vmcnt(26)
    v_dot2_f32_bf16 v42, v80, s69, 0
    v_dot2_f32_bf16 v43, v80, v80, 0
    s_waitcnt vmcnt(22)
    v_dot2_f32_bf16 v44, v96, s69, 0
    v_dot2_f32_bf16 v45, v96, v96, 0
    v_dot2_f32_bf16 v40, v65, s69, v40
    v_dot2_f32_bf16 v41, v65, v65, v41
    v_dot2_f32_bf16 v42, v81, s69, v42
    v_dot2_f32_bf16 v43, v81, v81, v43
    v_dot2_f32_bf16 v44, v97, s69, v44
    v_dot2_f32_bf16 v45, v97, v97, v45
    v_dot2_f32_bf16 v40, v66, s69, v40
    v_dot2_f32_bf16 v41, v66, v66, v41
    v_dot2_f32_bf16 v42, v82, s69, v42
    v_dot2_f32_bf16 v43, v82, v82, v43
    v_dot2_f32_bf16 v44, v98, s69, v44
    v_dot2_f32_bf16 v45, v98, v98, v45
    v_dot2_f32_bf16 v40, v67, s69, v40
    v_dot2_f32_bf16 v41, v67, v67, v41
    v_dot2_f32_bf16 v42, v83, s69, v42
    v_dot2_f32_bf16 v43, v83, v83, v43
    v_dot2_f32_bf16 v44, v99, s69, v44
    v_dot2_f32_bf16 v45, v99, v99, v45
    v_dot2_f32_bf16 v40, v68, s69, v40
    v_dot2_f32_bf16 v41, v68, v68, v41
    v_dot2_f32_bf16 v42, v84, s69, v42
    v_dot2_f32_bf16 v43, v84, v84, v43
    s_waitcnt vmcnt(21)
    v_dot2_f32_bf16 v44, v100, s69, v44
    v_dot2_f32_bf16 v45, v100, v100, v45
    v_dot2_f32_bf16 v40, v69, s69, v40
    v_dot2_f32_bf16 v41, v69, v69, v41
    v_dot2_f32_bf16 v42, v85, s69, v42
    v_dot2_f32_bf16 v43, v85, v85, v43
    v_dot2_f32_bf16 v44, v101, s69, v44
    v_dot2_f32_bf16 v45, v101, v101, v45
    s_add_u32 m0, s71, 0x1a000
    s_add_u32 s58, s16, 0xc0000
    buffer_load_dwordx4 v6, s[40:43], s58 offen offset:0 lds
    buffer_load_dwordx4 v6, s[40:43], s58 offen offset:1024 lds
    buffer_load_dwordx4 v6, s[40:43], s58 offen offset:2048 lds
    v_dot2_f32_bf16 v40, v70, s69, v40
    v_dot2_f32_bf16 v41, v70, v70, v41
    v_dot2_f32_bf16 v42, v86, s69, v42
    v_dot2_f32_bf16 v43, v86, v86, v43
    v_dot2_f32_bf16 v44, v102, s69, v44
    v_dot2_f32_bf16 v45, v102, v102, v45
    v_dot2_f32_bf16 v40, v71, s69, v40
    v_dot2_f32_bf16 v41, v71, v71, v41
    v_dot2_f32_bf16 v42, v87, s69, v42
    v_dot2_f32_bf16 v43, v87, v87, v43
    v_dot2_f32_bf16 v44, v103, s69, v44
    v_dot2_f32_bf16 v45, v103, v103, v45
    v_dot2_f32_bf16 v40, v72, s69, v40
    v_dot2_f32_bf16 v41, v72, v72, v41
    v_dot2_f32_bf16 v42, v88, s69, v42
    v_dot2_f32_bf16 v43, v88, v88, v43
    s_waitcnt vmcnt(23)
    v_dot2_f32_bf16 v44, v104, s69, v44
    v_dot2_f32_bf16 v45, v104, v104, v45
    v_dot2_f32_bf16 v40, v73, s69, v40
    v_dot2_f32_bf16 v41, v73, v73, v41
    v_dot2_f32_bf16 v42, v89, s69, v42
    v_dot2_f32_bf16 v43, v89, v89, v43
    v_dot2_f32_bf16 v44, v105, s69, v44
    v_dot2_f32_bf16 v45, v105, v105, v45
    v_dot2_f32_bf16 v40, v74, s69, v40
    v_dot2_f32_bf16 v41, v74, v74, v41
    v_dot2_f32_bf16 v42, v90, s69, v42
    v_dot2_f32_bf16 v43, v90, v90, v43
    v_dot2_f32_bf16 v44, v106, s69, v44
    v_dot2_f32_bf16 v45, v106, v106, v45
    v_dot2_f32_bf16 v40, v75, s69, v40
    v_dot2_f32_bf16 v41, v75, v75, v41
    v_dot2_f32_bf16 v42, v91, s69, v42
    v_dot2_f32_bf16 v43, v91, v91, v43
    v_dot2_f32_bf16 v44, v107, s69, v44
    v_dot2_f32_bf16 v45, v107, v107, v45
    s_add_u32 m0, s71, 0x1d000
    s_add_u32 s58, s16, 0x120000
    buffer_load_dwordx4 v6, s[40:43], s58 offen offset:0 lds
    buffer_load_dwordx4 v6, s[40:43], s58 offen offset:1024 lds
    buffer_load_dwordx4 v6, s[40:43], s58 offen offset:2048 lds
    v_dot2_f32_bf16 v40, v76, s69, v40
    v_dot2_f32_bf16 v41, v76, v76, v41
    v_dot2_f32_bf16 v42, v92, s69, v42
    v_dot2_f32_bf16 v43, v92, v92, v43
    s_waitcnt vmcnt(25)
    v_dot2_f32_bf16 v44, v108, s69, v44
    v_dot2_f32_bf16 v45, v108, v108, v45
    v_dot2_f32_bf16 v40, v77, s69, v40
    v_dot2_f32_bf16 v41, v77, v77, v41
    v_dot2_f32_bf16 v42, v93, s69, v42
    v_dot2_f32_bf16 v43, v93, v93, v43
    v_dot2_f32_bf16 v44, v109, s69, v44
    v_dot2_f32_bf16 v45, v109, v109, v45
    v_dot2_f32_bf16 v40, v78, s69, v40
    v_dot2_f32_bf16 v41, v78, v78, v41
    v_dot2_f32_bf16 v42, v94, s69, v42
    v_dot2_f32_bf16 v43, v94, v94, v43
    v_dot2_f32_bf16 v44, v110, s69, v44
    v_dot2_f32_bf16 v45, v110, v110, v45
    v_dot2_f32_bf16 v40, v79, s69, v40
    v_dot2_f32_bf16 v41, v79, v79, v41
    v_dot2_f32_bf16 v42, v95, s69, v42
    v_dot2_f32_bf16 v43, v95, v95, v43
    v_dot2_f32_bf16 v44, v111, s69, v44
    v_dot2_f32_bf16 v45, v111, v111, v45
    s_waitcnt vmcnt(24)
    v_dot2_f32_bf16 v46, v112, s69, 0
    v_dot2_f32_bf16 v47, v112, v112, 0
    s_waitcnt vmcnt(20)
    v_dot2_f32_bf16 v48, v128, s69, 0
    v_dot2_f32_bf16 v49, v128, v128, 0
    v_dot2_f32_bf16 v46, v113, s69, v46
    v_dot2_f32_bf16 v47, v113, v113, v47
    v_dot2_f32_bf16 v48, v129, s69, v48
    v_dot2_f32_bf16 v49, v129, v129, v49
    v_dot2_f32_bf16 v46, v114, s69, v46
    v_dot2_f32_bf16 v47, v114, v114, v47
    v_dot2_f32_bf16 v48, v130, s69, v48
    v_dot2_f32_bf16 v49, v130, v130, v49
    s_add_u32 m0, s71, 0x20000
    s_add_u32 s58, s17, 0x0
    buffer_load_dwordx4 v6, s[40:43], s58 offen offset:0 lds
    buffer_load_dwordx4 v6, s[40:43], s58 offen offset:1024 lds
    buffer_load_dwordx4 v6, s[40:43], s58 offen offset:2048 lds
    v_dot2_f32_bf16 v46, v115, s69, v46
    v_dot2_f32_bf16 v47, v115, v115, v47
    v_dot2_f32_bf16 v48, v131, s69, v48
    v_dot2_f32_bf16 v49, v131, v131, v49
    v_dot2_f32_bf16 v46, v116, s69, v46
    v_dot2_f32_bf16 v47, v116, v116, v47
    s_waitcnt vmcnt(22)
    v_dot2_f32_bf16 v48, v132, s69, v48
    v_dot2_f32_bf16 v49, v132, v132, v49
    v_dot2_f32_bf16 v46, v117, s69, v46
    v_dot2_f32_bf16 v47, v117, v117, v47
    v_dot2_f32_bf16 v48, v133, s69, v48
    v_dot2_f32_bf16 v49, v133, v133, v49
    v_dot2_f32_bf16 v46, v118, s69, v46
    v_dot2_f32_bf16 v47, v118, v118, v47
    v_dot2_f32_bf16 v48, v134, s69, v48
    v_dot2_f32_bf16 v49, v134, v134, v49
    v_dot2_f32_bf16 v46, v119, s69, v46
    v_dot2_f32_bf16 v47, v119, v119, v47
    v_dot2_f32_bf16 v48, v135, s69, v48
    v_dot2_f32_bf16 v49, v135, v135, v49
    v_dot2_f32_bf16 v46, v120, s69, v46
    v_dot2_f32_bf16 v47, v120, v120, v47
    s_waitcnt vmcnt(21)
    v_dot2_f32_bf16 v48, v136, s69, v48
    v_dot2_f32_bf16 v49, v136, v136, v49
    v_dot2_f32_bf16 v46, v121, s69, v46
    v_dot2_f32_bf16 v47, v121, v121, v47
    v_dot2_f32_bf16 v48, v137, s69, v48
    v_dot2_f32_bf16 v49, v137, v137, v49
    v_dot2_f32_bf16 v46, v122, s69, v46
    v_dot2_f32_bf16 v47, v122, v122, v47
    v_dot2_f32_bf16 v48, v138, s69, v48
    v_dot2_f32_bf16 v49, v138, v138, v49
    v_dot2_f32_bf16 v46, v123, s69, v46
    v_dot2_f32_bf16 v47, v123, v123, v47
    v_dot2_f32_bf16 v48, v139, s69, v48
    v_dot2_f32_bf16 v49, v139, v139, v49
    s_add_u32 m0, s71, 0x23000
    s_add_u32 s58, s17, 0x60000
    buffer_load_dwordx4 v6, s[40:43], s58 offen offset:0 lds
    buffer_load_dwordx4 v6, s[40:43], s58 offen offset:1024 lds
    buffer_load_dwordx4 v6, s[40:43], s58 offen offset:2048 lds
    v_dot2_f32_bf16 v46, v124, s69, v46
    v_dot2_f32_bf16 v47, v124, v124, v47
    s_waitcnt vmcnt(23)
    v_dot2_f32_bf16 v48, v140, s69, v48
    v_dot2_f32_bf16 v49, v140, v140, v49
    v_dot2_f32_bf16 v46, v125, s69, v46
    v_dot2_f32_bf16 v47, v125, v125, v47
    v_dot2_f32_bf16 v48, v141, s69, v48
    v_dot2_f32_bf16 v49, v141, v141, v49
    v_dot2_f32_bf16 v46, v126, s69, v46
    v_dot2_f32_bf16 v47, v126, v126, v47
    v_dot2_f32_bf16 v48, v142, s69, v48
    v_dot2_f32_bf16 v49, v142, v142, v49
    v_dot2_f32_bf16 v46, v127, s69, v46
    v_dot2_f32_bf16 v47, v127, v127, v47
    v_dot2_f32_bf16 v48, v143, s69, v48
    v_dot2_f32_bf16 v49, v143, v143, v49
    v_add_f32_dpp v40, v40, v40 quad_perm:[1,0,3,2] row_mask:0xf bank_mask:0xf
    v_add_f32_dpp v41, v41, v41 quad_perm:[1,0,3,2] row_mask:0xf bank_mask:0xf
    v_add_f32_dpp v42, v42, v42 quad_perm:[1,0,3,2] row_mask:0xf bank_mask:0xf
    v_add_f32_dpp v43, v43, v43 quad_perm:[1,0,3,2] row_mask:0xf bank_mask:0xf
    v_add_f32_dpp v44, v44, v44 quad_perm:[1,0,3,2] row_mask:0xf bank_mask:0xf
    v_add_f32_dpp v45, v45, v45 quad_perm:[1,0,3,2] row_mask:0xf bank_mask:0xf
    v_add_f32_dpp v46, v46, v46 quad_perm:[1,0,3,2] row_mask:0xf bank_mask:0xf
    v_add_f32_dpp v47, v47, v47 quad_perm:[1,0,3,2] row_mask:0xf bank_mask:0xf
    v_add_f32_dpp v48, v48, v48 quad_perm:[1,0,3,2] row_mask:0xf bank_mask:0xf
    v_add_f32_dpp v49, v49, v49 quad_perm:[1,0,3,2] row_mask:0xf bank_mask:0xf
    v_add_f32_dpp v40, v40, v40 quad_perm:[2,3,0,1] row_mask:0xf bank_mask:0xf
    v_add_f32_dpp v41, v41, v41 quad_perm:[2,3,0,1] row_mask:0xf bank_mask:0xf
    v_add_f32_dpp v42, v42, v42 quad_perm:[2,3,0,1] row_mask:0xf bank_mask:0xf
    v_add_f32_dpp v43, v43, v43 quad_perm:[2,3,0,1] row_mask:0xf bank_mask:0xf
    v_add_f32_dpp v44, v44, v44 quad_perm:[2,3,0,1] row_mask:0xf bank_mask:0xf
    v_add_f32_dpp v45, v45, v45 quad_perm:[2,3,0,1] row_mask:0xf bank_mask:0xf
    v_add_f32_dpp v46, v46, v46 quad_perm:[2,3,0,1] row_mask:0xf bank_mask:0xf
    v_add_f32_dpp v47, v47, v47 quad_perm:[2,3,0,1] row_mask:0xf bank_mask:0xf
    v_add_f32_dpp v48, v48, v48 quad_perm:[2,3,0,1] row_mask:0xf bank_mask:0xf
    v_add_f32_dpp v49, v49, v49 quad_perm:[2,3,0,1] row_mask:0xf bank_mask:0xf
    s_add_u32 m0, s22, 0x4400
    s_add_u32 s58, s17, 0xc0000
    buffer_load_dwordx4 v6, s[40:43], s58 offen offset:0 lds
    buffer_load_dwordx4 v6, s[40:43], s58 offen offset:1024 lds
    buffer_load_dwordx4 v6, s[40:43], s58 offen offset:2048 lds
    s_mov_b32 s58, 0x11111111
    s_mov_b32 s59, 0x11111111
    s_mov_b64 exec, s[58:59]
    ds_write_b64 v33, v[40:41] offset:1024
    ds_write_b64 v33, v[42:43] offset:1536
    ds_write_b64 v33, v[44:45] offset:2048
    ds_write_b64 v33, v[46:47] offset:2560
    ds_write_b64 v33, v[48:49] offset:3072
    s_mov_b64 exec, -1
    v_and_b32 v217, 0xffff0000, v140
    v_lshlrev_b32 v216, 16, v140
    v_and_b32 v219, 0xffff0000, v141
    v_lshlrev_b32 v218, 16, v141
    v_and_b32 v221, 0xffff0000, v142
    v_lshlrev_b32 v220, 16, v142
    v_and_b32 v223, 0xffff0000, v143
    v_lshlrev_b32 v222, 16, v143
    v_and_b32 v209, 0xffff0000, v136
    v_lshlrev_b32 v208, 16, v136
    v_and_b32 v211, 0xffff0000, v137
    v_lshlrev_b32 v210, 16, v137
    v_and_b32 v213, 0xffff0000, v138
    v_lshlrev_b32 v212, 16, v138
    v_and_b32 v215, 0xffff0000, v139
    v_lshlrev_b32 v214, 16, v139
    v_and_b32 v201, 0xffff0000, v132
    v_lshlrev_b32 v200, 16, v132
    v_and_b32 v203, 0xffff0000, v133
    v_lshlrev_b32 v202, 16, v133
    v_and_b32 v205, 0xffff0000, v134
    v_lshlrev_b32 v204, 16, v134
    v_and_b32 v207, 0xffff0000, v135
    v_lshlrev_b32 v206, 16, v135
    v_and_b32 v193, 0xffff0000, v128
    v_lshlrev_b32 v192, 16, v128
    v_and_b32 v195, 0xffff0000, v129
    v_lshlrev_b32 v194, 16, v129
    v_and_b32 v197, 0xffff0000, v130
    v_lshlrev_b32 v196, 16, v130
    v_and_b32 v199, 0xffff0000, v131
    v_lshlrev_b32 v198, 16, v131
    v_and_b32 v185, 0xffff0000, v124
    v_lshlrev_b32 v184, 16, v124
    v_and_b32 v187, 0xffff0000, v125
    v_lshlrev_b32 v186, 16, v125
    s_add_u32 m0, s22, 0x8400
    s_add_u32 s58, s17, 0x120000
    buffer_load_dwordx4 v6, s[40:43], s58 offen offset:0 lds
    buffer_load_dwordx4 v6, s[40:43], s58 offen offset:1024 lds
    buffer_load_dwordx4 v6, s[40:43], s58 offen offset:2048 lds
    v_and_b32 v189, 0xffff0000, v126
    v_lshlrev_b32 v188, 16, v126
    v_and_b32 v191, 0xffff0000, v127
    v_lshlrev_b32 v190, 16, v127
    v_and_b32 v177, 0xffff0000, v120
    v_lshlrev_b32 v176, 16, v120
    v_and_b32 v179, 0xffff0000, v121
    v_lshlrev_b32 v178, 16, v121
    v_and_b32 v181, 0xffff0000, v122
    v_lshlrev_b32 v180, 16, v122
    v_and_b32 v183, 0xffff0000, v123
    v_lshlrev_b32 v182, 16, v123
    v_and_b32 v169, 0xffff0000, v116
    v_lshlrev_b32 v168, 16, v116
    v_and_b32 v171, 0xffff0000, v117
    v_lshlrev_b32 v170, 16, v117
    v_and_b32 v173, 0xffff0000, v118
    v_lshlrev_b32 v172, 16, v118
    v_and_b32 v175, 0xffff0000, v119
    v_lshlrev_b32 v174, 16, v119
    v_and_b32 v161, 0xffff0000, v112
    v_lshlrev_b32 v160, 16, v112
    v_and_b32 v163, 0xffff0000, v113
    v_lshlrev_b32 v162, 16, v113
    v_and_b32 v165, 0xffff0000, v114
    v_lshlrev_b32 v164, 16, v114
    v_and_b32 v167, 0xffff0000, v115
    v_lshlrev_b32 v166, 16, v115
    v_and_b32 v153, 0xffff0000, v108
    v_lshlrev_b32 v152, 16, v108
    v_and_b32 v155, 0xffff0000, v109
    v_lshlrev_b32 v154, 16, v109
    v_and_b32 v157, 0xffff0000, v110
    v_lshlrev_b32 v156, 16, v110
    v_and_b32 v159, 0xffff0000, v111
    v_lshlrev_b32 v158, 16, v111
    s_add_u32 m0, s22, 0xc400
    s_add_u32 s58, s18, 0x0
    buffer_load_dwordx4 v6, s[40:43], s58 offen offset:0 lds
    buffer_load_dwordx4 v6, s[40:43], s58 offen offset:1024 lds
    buffer_load_dwordx4 v6, s[40:43], s58 offen offset:2048 lds
    v_and_b32 v145, 0xffff0000, v104
    v_lshlrev_b32 v144, 16, v104
    v_and_b32 v147, 0xffff0000, v105
    v_lshlrev_b32 v146, 16, v105
    v_and_b32 v149, 0xffff0000, v106
    v_lshlrev_b32 v148, 16, v106
    v_and_b32 v151, 0xffff0000, v107
    v_lshlrev_b32 v150, 16, v107
    s_waitcnt vmcnt(22)
    s_waitcnt lgkmcnt(0)
    s_barrier
    ds_read_b64_tr_b16 a[64:65], v14 offset:17408
    ds_read_b64_tr_b16 a[66:67], v14 offset:17920
    ds_read_b64_tr_b16 a[128:129], v14 offset:18432
    ds_read_b64_tr_b16 a[130:131], v14 offset:18944
    ds_read_b64_tr_b16 a[0:1], v14 offset:16384
    ds_read_b64_tr_b16 a[2:3], v14 offset:16896
    ds_read_b64_tr_b16 a[80:81], v14 offset:29696
    ds_read_b64_tr_b16 a[82:83], v14 offset:30208
    ds_read_b64_tr_b16 a[144:145], v14 offset:30720
    ds_read_b64_tr_b16 a[146:147], v14 offset:31232
    ds_read_b64_tr_b16 a[16:17], v14 offset:28672
    ds_read_b64_tr_b16 a[18:19], v14 offset:29184
    ds_read_b128 v[224:227], v32 offset:1024
    ds_read_b128 v[228:231], v32 offset:1040
    ds_read_b128 v[232:235], v32 offset:1536
    ds_read_b128 v[236:239], v32 offset:1552
    ds_read_b128 v[240:243], v32 offset:2048
    ds_read_b128 v[244:247], v32 offset:2064
    ds_read_b128 v[248:251], v32 offset:2560
    ds_read_b128 v[252:255], v32 offset:2576
    ds_read_b128 v[40:43], v32 offset:3072
    ds_read_b128 v[44:47], v32 offset:3088
    v_and_b32 v143, 0xffff0000, v103
    v_lshlrev_b32 v142, 16, v103
    v_and_b32 v141, 0xffff0000, v102
    v_lshlrev_b32 v140, 16, v102
    v_and_b32 v139, 0xffff0000, v101
    v_lshlrev_b32 v138, 16, v101
    v_and_b32 v137, 0xffff0000, v100
    v_lshlrev_b32 v136, 16, v100
    v_and_b32 v135, 0xffff0000, v99
    v_lshlrev_b32 v134, 16, v99
    v_and_b32 v133, 0xffff0000, v98
    v_lshlrev_b32 v132, 16, v98
    v_and_b32 v131, 0xffff0000, v97
    v_lshlrev_b32 v130, 16, v97
    v_and_b32 v129, 0xffff0000, v96
    v_lshlrev_b32 v128, 16, v96
    v_and_b32 v127, 0xffff0000, v95
    v_lshlrev_b32 v126, 16, v95
    v_and_b32 v125, 0xffff0000, v94
    v_lshlrev_b32 v124, 16, v94
    v_and_b32 v123, 0xffff0000, v93
    v_lshlrev_b32 v122, 16, v93
    v_and_b32 v121, 0xffff0000, v92
    v_lshlrev_b32 v120, 16, v92
    v_and_b32 v119, 0xffff0000, v91
    v_lshlrev_b32 v118, 16, v91
    v_and_b32 v117, 0xffff0000, v90
    v_lshlrev_b32 v116, 16, v90
    s_add_u32 m0, s22, 0x10400
    s_add_u32 s58, s18, 0x60000
    buffer_load_dwordx4 v6, s[40:43], s58 offen offset:0 lds
    buffer_load_dwordx4 v6, s[40:43], s58 offen offset:1024 lds
    buffer_load_dwordx4 v6, s[40:43], s58 offen offset:2048 lds
    v_and_b32 v115, 0xffff0000, v89
    v_lshlrev_b32 v114, 16, v89
    v_and_b32 v113, 0xffff0000, v88
    v_lshlrev_b32 v112, 16, v88
    v_and_b32 v111, 0xffff0000, v87
    v_lshlrev_b32 v110, 16, v87
    v_and_b32 v109, 0xffff0000, v86
    v_lshlrev_b32 v108, 16, v86
    v_and_b32 v107, 0xffff0000, v85
    v_lshlrev_b32 v106, 16, v85
    v_and_b32 v105, 0xffff0000, v84
    v_lshlrev_b32 v104, 16, v84
    v_and_b32 v103, 0xffff0000, v83
    v_lshlrev_b32 v102, 16, v83
    v_and_b32 v101, 0xffff0000, v82
    v_lshlrev_b32 v100, 16, v82
    v_and_b32 v99, 0xffff0000, v81
    v_lshlrev_b32 v98, 16, v81
    v_and_b32 v97, 0xffff0000, v80
    v_lshlrev_b32 v96, 16, v80
    v_and_b32 v95, 0xffff0000, v79
    v_lshlrev_b32 v94, 16, v79
    v_and_b32 v93, 0xffff0000, v78
    v_lshlrev_b32 v92, 16, v78
    v_and_b32 v91, 0xffff0000, v77
    v_lshlrev_b32 v90, 16, v77
    v_and_b32 v89, 0xffff0000, v76
    v_lshlrev_b32 v88, 16, v76
    v_and_b32 v87, 0xffff0000, v75
    v_lshlrev_b32 v86, 16, v75
    v_and_b32 v85, 0xffff0000, v74
    v_lshlrev_b32 v84, 16, v74
    v_and_b32 v83, 0xffff0000, v73
    v_lshlrev_b32 v82, 16, v73
    v_and_b32 v81, 0xffff0000, v72
    v_lshlrev_b32 v80, 16, v72
    v_and_b32 v79, 0xffff0000, v71
    v_lshlrev_b32 v78, 16, v71
    v_and_b32 v77, 0xffff0000, v70
    v_lshlrev_b32 v76, 16, v70
    v_and_b32 v75, 0xffff0000, v69
    v_lshlrev_b32 v74, 16, v69
    v_and_b32 v73, 0xffff0000, v68
    v_lshlrev_b32 v72, 16, v68
    v_and_b32 v71, 0xffff0000, v67
    v_lshlrev_b32 v70, 16, v67
    v_and_b32 v69, 0xffff0000, v66
    v_lshlrev_b32 v68, 16, v66
    v_and_b32 v67, 0xffff0000, v65
    v_lshlrev_b32 v66, 16, v65
    v_and_b32 v65, 0xffff0000, v64
    v_lshlrev_b32 v64, 16, v64
    s_waitcnt vmcnt(18)
    s_waitcnt lgkmcnt(0)
    s_barrier
    ds_read_b64_tr_b16 a[96:97], v14 offset:41984
    ds_read_b64_tr_b16 a[98:99], v14 offset:42496
    ds_read_b64_tr_b16 a[160:161], v14 offset:43008
    ds_read_b64_tr_b16 a[162:163], v14 offset:43520
    ds_read_b64_tr_b16 a[32:33], v14 offset:40960
    ds_read_b64_tr_b16 a[34:35], v14 offset:41472
    ds_read_b64_tr_b16 a[112:113], v14 offset:54272
    ds_read_b64_tr_b16 a[114:115], v14 offset:54784
    ds_read_b64_tr_b16 a[176:177], v14 offset:55296
    ds_read_b64_tr_b16 a[178:179], v14 offset:55808
    ds_read_b64_tr_b16 a[48:49], v14 offset:53248
    ds_read_b64_tr_b16 a[50:51], v14 offset:53760
    v_and_b32 v26, 7, v1
    v_lshlrev_b32 v26, 2, v26
    s_lshl_b32 s59, s52, 7
    s_mov_b32 s58, 0x4000
    s_add_u32 s59, s59, 0x1000
    buffer_load_dword v26, v26, s[4:7], s59 offen offset:32 sc1
    buffer_load_dwordx4 v[28:31], v36, s[4:7], s58 offen sc1
    v_pk_add_f32 v[224:225], v[224:225], v[226:227]
    v_pk_add_f32 v[232:233], v[232:233], v[234:235]
    v_pk_add_f32 v[240:241], v[240:241], v[242:243]
    v_pk_add_f32 v[248:249], v[248:249], v[250:251]
    v_pk_add_f32 v[40:41], v[40:41], v[42:43]
    v_pk_add_f32 v[228:229], v[228:229], v[230:231]
    v_pk_add_f32 v[236:237], v[236:237], v[238:239]
    v_pk_add_f32 v[244:245], v[244:245], v[246:247]
    v_pk_add_f32 v[252:253], v[252:253], v[254:255]
    v_pk_add_f32 v[44:45], v[44:45], v[46:47]
    s_add_u32 m0, s71, 0x14000
    s_add_u32 s58, s18, 0xc0000
    buffer_load_dwordx4 v6, s[40:43], s58 offen offset:0 lds
    buffer_load_dwordx4 v6, s[40:43], s58 offen offset:1024 lds
    buffer_load_dwordx4 v6, s[40:43], s58 offen offset:2048 lds
    v_pk_add_f32 v[224:225], v[224:225], v[228:229]
    v_pk_add_f32 v[232:233], v[232:233], v[236:237]
    v_pk_add_f32 v[240:241], v[240:241], v[244:245]
    v_pk_add_f32 v[248:249], v[248:249], v[252:253]
    v_pk_add_f32 v[40:41], v[40:41], v[44:45]
    v_mul_f32 v224, 0x3b000000, v224
    v_mul_f32 v232, 0x3b000000, v232
    v_mul_f32 v240, 0x3b000000, v240
    v_mul_f32 v248, 0x3b000000, v248
    v_mul_f32 v40, 0x3b000000, v40
    v_mul_f32 v225, 0x3b000000, v225
    v_mul_f32 v233, 0x3b000000, v233
    v_mul_f32 v241, 0x3b000000, v241
    v_mul_f32 v249, 0x3b000000, v249
    v_mul_f32 v41, 0x3b000000, v41
    v_fma_f32 v225, -v224, v224, v225
    v_fma_f32 v233, -v232, v232, v233
    v_fma_f32 v241, -v240, v240, v241
    v_fma_f32 v249, -v248, v248, v249
    v_fma_f32 v41, -v40, v40, v41
    s_add_u32 m0, s71, 0x17000
    s_add_u32 s58, s18, 0x120000
    buffer_load_dwordx4 v6, s[40:43], s58 offen offset:0 lds
    buffer_load_dwordx4 v6, s[40:43], s58 offen offset:1024 lds
    buffer_load_dwordx4 v6, s[40:43], s58 offen offset:2048 lds
    v_max_f32 v225, 0, v225
    v_max_f32 v233, 0, v233
    v_max_f32 v241, 0, v241
    v_max_f32 v249, 0, v249
    v_max_f32 v41, 0, v41
    v_add_f32 v225, 0x3727c5ac, v225
    v_add_f32 v233, 0x3727c5ac, v233
    v_add_f32 v241, 0x3727c5ac, v241
    v_add_f32 v249, 0x3727c5ac, v249
    v_add_f32 v41, 0x3727c5ac, v41
    v_rsq_f32 v16, v225
    v_rsq_f32 v18, v233
    v_rsq_f32 v20, v241
    v_rsq_f32 v22, v249
    v_rsq_f32 v24, v41
    v_mul_f32 v17, -v224, v16
    v_mul_f32 v19, -v232, v18
    v_mul_f32 v21, -v240, v20
    v_mul_f32 v23, -v248, v22
    v_mul_f32 v25, -v40, v24
    s_waitcnt vmcnt(20)
    s_waitcnt lgkmcnt(0)
    s_barrier
    ds_read_b64_tr_b16 a[68:69], v15 offset:1024
    ds_read_b64_tr_b16 a[70:71], v15 offset:1536
    ds_read_b64_tr_b16 a[132:133], v15 offset:2048
    ds_read_b64_tr_b16 a[134:135], v15 offset:2560
    ds_read_b64_tr_b16 a[4:5], v15 offset:0
    ds_read_b64_tr_b16 a[6:7], v15 offset:512
    ds_read_b64_tr_b16 a[84:85], v15 offset:13312
    ds_read_b64_tr_b16 a[86:87], v15 offset:13824
    ds_read_b64_tr_b16 a[148:149], v15 offset:14336
    ds_read_b64_tr_b16 a[150:151], v15 offset:14848
    ds_read_b64_tr_b16 a[20:21], v15 offset:12288
    ds_read_b64_tr_b16 a[22:23], v15 offset:12800
    v_pk_fma_f32 v[64:65], v[64:65], v[16:17], v[16:17] op_sel:[0,0,1] op_sel_hi:[1,0,1]
    v_pk_fma_f32 v[66:67], v[66:67], v[16:17], v[16:17] op_sel:[0,0,1] op_sel_hi:[1,0,1]
    v_pk_fma_f32 v[68:69], v[68:69], v[16:17], v[16:17] op_sel:[0,0,1] op_sel_hi:[1,0,1]
    v_pk_fma_f32 v[70:71], v[70:71], v[16:17], v[16:17] op_sel:[0,0,1] op_sel_hi:[1,0,1]
    v_pk_fma_f32 v[72:73], v[72:73], v[16:17], v[16:17] op_sel:[0,0,1] op_sel_hi:[1,0,1]
    v_pk_fma_f32 v[74:75], v[74:75], v[16:17], v[16:17] op_sel:[0,0,1] op_sel_hi:[1,0,1]
    v_pk_fma_f32 v[76:77], v[76:77], v[16:17], v[16:17] op_sel:[0,0,1] op_sel_hi:[1,0,1]
    v_pk_fma_f32 v[78:79], v[78:79], v[16:17], v[16:17] op_sel:[0,0,1] op_sel_hi:[1,0,1]
    v_pk_fma_f32 v[80:81], v[80:81], v[16:17], v[16:17] op_sel:[0,0,1] op_sel_hi:[1,0,1]
    v_pk_fma_f32 v[82:83], v[82:83], v[16:17], v[16:17] op_sel:[0,0,1] op_sel_hi:[1,0,1]
    v_pk_fma_f32 v[84:85], v[84:85], v[16:17], v[16:17] op_sel:[0,0,1] op_sel_hi:[1,0,1]
    v_pk_fma_f32 v[86:87], v[86:87], v[16:17], v[16:17] op_sel:[0,0,1] op_sel_hi:[1,0,1]
    v_pk_fma_f32 v[88:89], v[88:89], v[16:17], v[16:17] op_sel:[0,0,1] op_sel_hi:[1,0,1]
    v_pk_fma_f32 v[90:91], v[90:91], v[16:17], v[16:17] op_sel:[0,0,1] op_sel_hi:[1,0,1]
    v_pk_fma_f32 v[92:93], v[92:93], v[16:17], v[16:17] op_sel:[0,0,1] op_sel_hi:[1,0,1]
    v_pk_fma_f32 v[94:95], v[94:95], v[16:17], v[16:17] op_sel:[0,0,1] op_sel_hi:[1,0,1]
    v_pk_fma_f32 v[96:97], v[96:97], v[18:19], v[18:19] op_sel:[0,0,1] op_sel_hi:[1,0,1]
    v_pk_fma_f32 v[98:99], v[98:99], v[18:19], v[18:19] op_sel:[0,0,1] op_sel_hi:[1,0,1]
    v_pk_fma_f32 v[100:101], v[100:101], v[18:19], v[18:19] op_sel:[0,0,1] op_sel_hi:[1,0,1]
    v_pk_fma_f32 v[102:103], v[102:103], v[18:19], v[18:19] op_sel:[0,0,1] op_sel_hi:[1,0,1]
    v_pk_fma_f32 v[104:105], v[104:105], v[18:19], v[18:19] op_sel:[0,0,1] op_sel_hi:[1,0,1]
    v_pk_fma_f32 v[106:107], v[106:107], v[18:19], v[18:19] op_sel:[0,0,1] op_sel_hi:[1,0,1]
    v_pk_fma_f32 v[108:109], v[108:109], v[18:19], v[18:19] op_sel:[0,0,1] op_sel_hi:[1,0,1]
    v_pk_fma_f32 v[110:111], v[110:111], v[18:19], v[18:19] op_sel:[0,0,1] op_sel_hi:[1,0,1]
    v_pk_fma_f32 v[112:113], v[112:113], v[18:19], v[18:19] op_sel:[0,0,1] op_sel_hi:[1,0,1]
    v_pk_fma_f32 v[114:115], v[114:115], v[18:19], v[18:19] op_sel:[0,0,1] op_sel_hi:[1,0,1]
    v_pk_fma_f32 v[116:117], v[116:117], v[18:19], v[18:19] op_sel:[0,0,1] op_sel_hi:[1,0,1]
    v_pk_fma_f32 v[118:119], v[118:119], v[18:19], v[18:19] op_sel:[0,0,1] op_sel_hi:[1,0,1]
    v_pk_fma_f32 v[120:121], v[120:121], v[18:19], v[18:19] op_sel:[0,0,1] op_sel_hi:[1,0,1]
    v_pk_fma_f32 v[122:123], v[122:123], v[18:19], v[18:19] op_sel:[0,0,1] op_sel_hi:[1,0,1]
    v_pk_fma_f32 v[124:125], v[124:125], v[18:19], v[18:19] op_sel:[0,0,1] op_sel_hi:[1,0,1]
    v_pk_fma_f32 v[126:127], v[126:127], v[18:19], v[18:19] op_sel:[0,0,1] op_sel_hi:[1,0,1]
    v_pk_fma_f32 v[128:129], v[128:129], v[20:21], v[20:21] op_sel:[0,0,1] op_sel_hi:[1,0,1]
    v_pk_fma_f32 v[130:131], v[130:131], v[20:21], v[20:21] op_sel:[0,0,1] op_sel_hi:[1,0,1]
    v_pk_fma_f32 v[132:133], v[132:133], v[20:21], v[20:21] op_sel:[0,0,1] op_sel_hi:[1,0,1]
    v_pk_fma_f32 v[134:135], v[134:135], v[20:21], v[20:21] op_sel:[0,0,1] op_sel_hi:[1,0,1]
    v_pk_fma_f32 v[136:137], v[136:137], v[20:21], v[20:21] op_sel:[0,0,1] op_sel_hi:[1,0,1]
    v_pk_fma_f32 v[138:139], v[138:139], v[20:21], v[20:21] op_sel:[0,0,1] op_sel_hi:[1,0,1]
    v_pk_fma_f32 v[140:141], v[140:141], v[20:21], v[20:21] op_sel:[0,0,1] op_sel_hi:[1,0,1]
    v_pk_fma_f32 v[142:143], v[142:143], v[20:21], v[20:21] op_sel:[0,0,1] op_sel_hi:[1,0,1]
    s_waitcnt vmcnt(14)
    s_waitcnt lgkmcnt(0)
    s_barrier
    ds_read_b64_tr_b16 a[100:101], v27 offset:2048
    ds_read_b64_tr_b16 a[102:103], v27 offset:2560
    ds_read_b64_tr_b16 a[164:165], v27 offset:3072
    ds_read_b64_tr_b16 a[166:167], v27 offset:3584
    ds_read_b64_tr_b16 a[36:37], v27 offset:1024
    ds_read_b64_tr_b16 a[38:39], v27 offset:1536
    ds_read_b64_tr_b16 a[116:117], v27 offset:18432
    ds_read_b64_tr_b16 a[118:119], v27 offset:18944
    ds_read_b64_tr_b16 a[180:181], v27 offset:19456
    ds_read_b64_tr_b16 a[182:183], v27 offset:19968
    ds_read_b64_tr_b16 a[52:53], v27 offset:17408
    ds_read_b64_tr_b16 a[54:55], v27 offset:17920
    v_pk_fma_f32 v[144:145], v[144:145], v[20:21], v[20:21] op_sel:[0,0,1] op_sel_hi:[1,0,1]
    v_pk_fma_f32 v[146:147], v[146:147], v[20:21], v[20:21] op_sel:[0,0,1] op_sel_hi:[1,0,1]
    v_pk_fma_f32 v[148:149], v[148:149], v[20:21], v[20:21] op_sel:[0,0,1] op_sel_hi:[1,0,1]
    v_pk_fma_f32 v[150:151], v[150:151], v[20:21], v[20:21] op_sel:[0,0,1] op_sel_hi:[1,0,1]
    v_pk_fma_f32 v[152:153], v[152:153], v[20:21], v[20:21] op_sel:[0,0,1] op_sel_hi:[1,0,1]
    v_pk_fma_f32 v[154:155], v[154:155], v[20:21], v[20:21] op_sel:[0,0,1] op_sel_hi:[1,0,1]
    v_pk_fma_f32 v[156:157], v[156:157], v[20:21], v[20:21] op_sel:[0,0,1] op_sel_hi:[1,0,1]
    v_pk_fma_f32 v[158:159], v[158:159], v[20:21], v[20:21] op_sel:[0,0,1] op_sel_hi:[1,0,1]
    v_pk_fma_f32 v[160:161], v[160:161], v[22:23], v[22:23] op_sel:[0,0,1] op_sel_hi:[1,0,1]
    v_pk_fma_f32 v[162:163], v[162:163], v[22:23], v[22:23] op_sel:[0,0,1] op_sel_hi:[1,0,1]
    v_pk_fma_f32 v[164:165], v[164:165], v[22:23], v[22:23] op_sel:[0,0,1] op_sel_hi:[1,0,1]
    v_pk_fma_f32 v[166:167], v[166:167], v[22:23], v[22:23] op_sel:[0,0,1] op_sel_hi:[1,0,1]
    v_pk_fma_f32 v[168:169], v[168:169], v[22:23], v[22:23] op_sel:[0,0,1] op_sel_hi:[1,0,1]
    v_pk_fma_f32 v[170:171], v[170:171], v[22:23], v[22:23] op_sel:[0,0,1] op_sel_hi:[1,0,1]
    v_pk_fma_f32 v[172:173], v[172:173], v[22:23], v[22:23] op_sel:[0,0,1] op_sel_hi:[1,0,1]
    v_pk_fma_f32 v[174:175], v[174:175], v[22:23], v[22:23] op_sel:[0,0,1] op_sel_hi:[1,0,1]
    v_pk_fma_f32 v[176:177], v[176:177], v[22:23], v[22:23] op_sel:[0,0,1] op_sel_hi:[1,0,1]
    v_pk_fma_f32 v[178:179], v[178:179], v[22:23], v[22:23] op_sel:[0,0,1] op_sel_hi:[1,0,1]
    v_pk_fma_f32 v[180:181], v[180:181], v[22:23], v[22:23] op_sel:[0,0,1] op_sel_hi:[1,0,1]
    v_pk_fma_f32 v[182:183], v[182:183], v[22:23], v[22:23] op_sel:[0,0,1] op_sel_hi:[1,0,1]
    v_pk_fma_f32 v[184:185], v[184:185], v[22:23], v[22:23] op_sel:[0,0,1] op_sel_hi:[1,0,1]
    v_pk_fma_f32 v[186:187], v[186:187], v[22:23], v[22:23] op_sel:[0,0,1] op_sel_hi:[1,0,1]
    v_pk_fma_f32 v[188:189], v[188:189], v[22:23], v[22:23] op_sel:[0,0,1] op_sel_hi:[1,0,1]
    v_pk_fma_f32 v[190:191], v[190:191], v[22:23], v[22:23] op_sel:[0,0,1] op_sel_hi:[1,0,1]
    v_pk_fma_f32 v[192:193], v[192:193], v[24:25], v[24:25] op_sel:[0,0,1] op_sel_hi:[1,0,1]
    v_pk_fma_f32 v[194:195], v[194:195], v[24:25], v[24:25] op_sel:[0,0,1] op_sel_hi:[1,0,1]
    v_pk_fma_f32 v[196:197], v[196:197], v[24:25], v[24:25] op_sel:[0,0,1] op_sel_hi:[1,0,1]
    v_pk_fma_f32 v[198:199], v[198:199], v[24:25], v[24:25] op_sel:[0,0,1] op_sel_hi:[1,0,1]
    v_pk_fma_f32 v[200:201], v[200:201], v[24:25], v[24:25] op_sel:[0,0,1] op_sel_hi:[1,0,1]
    v_pk_fma_f32 v[202:203], v[202:203], v[24:25], v[24:25] op_sel:[0,0,1] op_sel_hi:[1,0,1]
    v_pk_fma_f32 v[204:205], v[204:205], v[24:25], v[24:25] op_sel:[0,0,1] op_sel_hi:[1,0,1]
    v_pk_fma_f32 v[206:207], v[206:207], v[24:25], v[24:25] op_sel:[0,0,1] op_sel_hi:[1,0,1]
    v_pk_fma_f32 v[208:209], v[208:209], v[24:25], v[24:25] op_sel:[0,0,1] op_sel_hi:[1,0,1]
    v_pk_fma_f32 v[210:211], v[210:211], v[24:25], v[24:25] op_sel:[0,0,1] op_sel_hi:[1,0,1]
    v_pk_fma_f32 v[212:213], v[212:213], v[24:25], v[24:25] op_sel:[0,0,1] op_sel_hi:[1,0,1]
    v_pk_fma_f32 v[214:215], v[214:215], v[24:25], v[24:25] op_sel:[0,0,1] op_sel_hi:[1,0,1]
    v_pk_fma_f32 v[216:217], v[216:217], v[24:25], v[24:25] op_sel:[0,0,1] op_sel_hi:[1,0,1]
    v_pk_fma_f32 v[218:219], v[218:219], v[24:25], v[24:25] op_sel:[0,0,1] op_sel_hi:[1,0,1]
    v_pk_fma_f32 v[220:221], v[220:221], v[24:25], v[24:25] op_sel:[0,0,1] op_sel_hi:[1,0,1]
    v_pk_fma_f32 v[222:223], v[222:223], v[24:25], v[24:25] op_sel:[0,0,1] op_sel_hi:[1,0,1]
    s_waitcnt vmcnt(6)
    s_mov_b32 s68, s39
    s_branch L_cc_4
L_cp_3:
    s_sleep 8
    s_mov_b32 s58, 0x4000
    buffer_load_dwordx4 v[28:31], v36, s[4:7], s58 offen sc1
    s_waitcnt vmcnt(0)
L_cc_4:
    v_mov_b32 v224, s38
    v_mov_b32 v225, s38
    v_min3_u32 v224, v224, v29, v31
    v_max3_u32 v225, v225, v29, v31
    v_cmp_ne_u32 vcc, v224, v225
    s_add_u32 s68, s68, 1
    s_cbranch_vccz L_pdone_5
    s_cmp_lt_u32 s68, 20000
    s_cbranch_scc1 L_cp_3
    s_mov_b32 s39, 20000
L_pdone_5:
    v_cmp_eq_u32 vcc, s99, v26
    v_and_b32 v29, 0xffff0000, v28
    v_lshlrev_b32 v28, 16, v28
    v_and_b32 v31, 0xffff0000, v30
    v_lshlrev_b32 v30, 16, v30
    ds_write_b128 v37, v[28:31]
    s_cmp_eq_u64 vcc, -1
    s_cselect_b64 s[34:35], -1, 0
    s_waitcnt lgkmcnt(0)
    s_barrier
    ds_read_b64_tr_b16 a[72:73], v27 offset:34816
    ds_read_b64_tr_b16 a[74:75], v27 offset:35328
    ds_read_b64_tr_b16 a[136:137], v27 offset:35840
    ds_read_b64_tr_b16 a[138:139], v27 offset:36352
    ds_read_b64_tr_b16 a[8:9], v27 offset:33792
    ds_read_b64_tr_b16 a[10:11], v27 offset:34304
    ds_read_b64_tr_b16 a[88:89], v27 offset:51200
    ds_read_b64_tr_b16 a[90:91], v27 offset:51712
    ds_read_b64_tr_b16 a[152:153], v27 offset:52224
    ds_read_b64_tr_b16 a[154:155], v27 offset:52736
    ds_read_b64_tr_b16 a[24:25], v27 offset:50176
    ds_read_b64_tr_b16 a[26:27], v27 offset:50688
    ds_read_b128 v[16:19], v5 offset:0
    ds_read_b128 v[20:23], v5 offset:16
    ds_read_b128 v[24:27], v5 offset:2048
    ds_read_b128 v[28:31], v5 offset:2064
    s_waitcnt lgkmcnt(1)
    v_pk_fma_f32 v[64:65], v[64:65], v[24:25], v[16:17]
    v_pk_fma_f32 v[66:67], v[66:67], v[26:27], v[18:19]
    s_waitcnt lgkmcnt(0)
    v_pk_fma_f32 v[68:69], v[68:69], v[28:29], v[20:21]
    v_pk_fma_f32 v[70:71], v[70:71], v[30:31], v[22:23]
    v_cvt_pk_bf16_f32 v32, v64, v65
    v_cvt_pk_bf16_f32 v33, v66, v67
    v_cvt_pk_bf16_f32 v34, v68, v69
    v_cvt_pk_bf16_f32 v35, v70, v71
    ds_write_b128 v12, v[32:35] offset:0
    v_pk_fma_f32 v[96:97], v[96:97], v[24:25], v[16:17]
    v_pk_fma_f32 v[98:99], v[98:99], v[26:27], v[18:19]
    v_pk_fma_f32 v[100:101], v[100:101], v[28:29], v[20:21]
    v_pk_fma_f32 v[102:103], v[102:103], v[30:31], v[22:23]
    v_cvt_pk_bf16_f32 v36, v96, v97
    v_cvt_pk_bf16_f32 v37, v98, v99
    v_cvt_pk_bf16_f32 v38, v100, v101
    v_cvt_pk_bf16_f32 v39, v102, v103
    ds_write_b128 v12, v[36:39] offset:16384
    v_pk_fma_f32 v[128:129], v[128:129], v[24:25], v[16:17]
    v_pk_fma_f32 v[130:131], v[130:131], v[26:27], v[18:19]
    v_pk_fma_f32 v[132:133], v[132:133], v[28:29], v[20:21]
    v_pk_fma_f32 v[134:135], v[134:135], v[30:31], v[22:23]
    v_cvt_pk_bf16_f32 v32, v128, v129
    v_cvt_pk_bf16_f32 v33, v130, v131
    v_cvt_pk_bf16_f32 v34, v132, v133
    v_cvt_pk_bf16_f32 v35, v134, v135
    ds_write_b128 v12, v[32:35] offset:32768
    v_pk_fma_f32 v[160:161], v[160:161], v[24:25], v[16:17]
    v_pk_fma_f32 v[162:163], v[162:163], v[26:27], v[18:19]
    v_pk_fma_f32 v[164:165], v[164:165], v[28:29], v[20:21]
    v_pk_fma_f32 v[166:167], v[166:167], v[30:31], v[22:23]
    v_cvt_pk_bf16_f32 v36, v160, v161
    v_cvt_pk_bf16_f32 v37, v162, v163
    v_cvt_pk_bf16_f32 v38, v164, v165
    v_cvt_pk_bf16_f32 v39, v166, v167
    ds_write_b128 v13, v[36:39] offset:0
    v_pk_fma_f32 v[192:193], v[192:193], v[24:25], v[16:17]
    v_pk_fma_f32 v[194:195], v[194:195], v[26:27], v[18:19]
    v_pk_fma_f32 v[196:197], v[196:197], v[28:29], v[20:21]
    v_pk_fma_f32 v[198:199], v[198:199], v[30:31], v[22:23]
    v_cvt_pk_bf16_f32 v32, v192, v193
    v_cvt_pk_bf16_f32 v33, v194, v195
    v_cvt_pk_bf16_f32 v34, v196, v197
    v_cvt_pk_bf16_f32 v35, v198, v199
    ds_write_b128 v13, v[32:35] offset:16384
    s_waitcnt lgkmcnt(0)
    s_barrier
    ds_read_b128 v[40:43], v56 offset:0
    ds_read_b128 v[44:47], v56 offset:16384
    ds_read_b128 v[48:51], v56 offset:32768
    ds_read_b128 v[52:55], v57 offset:0
    s_waitcnt lgkmcnt(3)
    v_mfma_f32_16x16x32_bf16 v[224:227], a[64:67], v[40:43], 0
    ds_read_b128 v[16:19], v5 offset:128
    ds_read_b128 v[20:23], v5 offset:144
    ds_read_b128 v[24:27], v5 offset:2176
    ds_read_b128 v[28:31], v5 offset:2192
    s_add_u32 m0, s71, 0x1a000
    s_add_u32 s58, s19, 0x0
    buffer_load_dwordx4 v6, s[40:43], s58 offen offset:0 lds
    buffer_load_dwordx4 v6, s[40:43], s58 offen offset:1024 lds
    buffer_load_dwordx4 v6, s[40:43], s58 offen offset:2048 lds
    v_mfma_f32_16x16x32_bf16 v[244:247], v[40:43], a[128:131], 0
    ds_read_b128 v[40:43], v57 offset:16384
    s_waitcnt lgkmcnt(7)
    v_mfma_f32_16x16x32_bf16 v[228:231], a[64:67], v[44:47], 0
    s_waitcnt lgkmcnt(2)
    v_fma_f32 v72, v72, v24, v16
    v_mfma_f32_16x16x32_bf16 v[248:251], v[44:47], a[128:131], 0
    v_fma_f32 v73, v73, v25, v17
    v_fma_f32 v74, v74, v26, v18
    v_mfma_f32_16x16x32_bf16 v[96:99], a[0:3], v[44:47], 0
    v_fma_f32 v75, v75, v27, v19
    s_waitcnt lgkmcnt(1)
    v_fma_f32 v76, v76, v28, v20
    ds_read_b128 v[44:47], v56 offset:4096
    v_mfma_f32_16x16x32_bf16 v[232:235], a[64:67], v[48:51], 0
    v_fma_f32 v77, v77, v29, v21
    v_fma_f32 v78, v78, v30, v22
    v_mfma_f32_16x16x32_bf16 v[252:255], v[48:51], a[128:131], 0
    v_fma_f32 v79, v79, v31, v23
    v_cvt_pk_bf16_f32 v32, v72, v73
    s_add_u32 m0, s71, 0x1d000
    s_add_u32 s58, s19, 0x60000
    buffer_load_dwordx4 v6, s[40:43], s58 offen offset:0 lds
    buffer_load_dwordx4 v6, s[40:43], s58 offen offset:1024 lds
    buffer_load_dwordx4 v6, s[40:43], s58 offen offset:2048 lds
    v_mfma_f32_16x16x32_bf16 v[100:103], a[0:3], v[48:51], 0
    ds_read_b128 v[48:51], v56 offset:20480
    v_mfma_f32_16x16x32_bf16 v[236:239], a[64:67], v[52:55], 0
    v_cvt_pk_bf16_f32 v33, v74, v75
    v_mfma_f32_16x16x32_bf16 v[64:67], v[52:55], a[128:131], 0
    v_cvt_pk_bf16_f32 v34, v76, v77
    v_cvt_pk_bf16_f32 v35, v78, v79
    v_mfma_f32_16x16x32_bf16 v[128:131], a[0:3], v[52:55], 0
    ds_write_b128 v12, v[32:35] offset:1024
    v_fma_f32 v104, v104, v24, v16
    ds_read_b128 v[52:55], v56 offset:36864
    s_waitcnt lgkmcnt(4)
    v_mfma_f32_16x16x32_bf16 v[240:243], a[64:67], v[40:43], 0
    v_fma_f32 v105, v105, v25, v17
    v_fma_f32 v106, v106, v26, v18
    v_mfma_f32_16x16x32_bf16 v[68:71], v[40:43], a[128:131], 0
    v_fma_f32 v107, v107, v27, v19
    v_fma_f32 v108, v108, v28, v20
    s_add_u32 m0, s71, 0x20000
    s_add_u32 s58, s19, 0xc0000
    buffer_load_dwordx4 v6, s[40:43], s58 offen offset:0 lds
    buffer_load_dwordx4 v6, s[40:43], s58 offen offset:1024 lds
    buffer_load_dwordx4 v6, s[40:43], s58 offen offset:2048 lds
    v_mfma_f32_16x16x32_bf16 v[132:135], a[0:3], v[40:43], 0
    ds_read_b128 v[40:43], v57 offset:4096
    s_waitcnt lgkmcnt(4)
    v_mfma_f32_16x16x32_bf16 v[224:227], a[80:83], v[44:47], v[224:227]
    v_fma_f32 v109, v109, v29, v21
    v_mfma_f32_16x16x32_bf16 v[244:247], v[44:47], a[144:147], v[244:247]
    v_fma_f32 v110, v110, v30, v22
    v_fma_f32 v111, v111, v31, v23
    ds_read_b128 v[44:47], v57 offset:20480
    s_waitcnt lgkmcnt(4)
    v_mfma_f32_16x16x32_bf16 v[228:231], a[80:83], v[48:51], v[228:231]
    v_cvt_pk_bf16_f32 v36, v104, v105
    v_cvt_pk_bf16_f32 v37, v106, v107
    v_mfma_f32_16x16x32_bf16 v[248:251], v[48:51], a[144:147], v[248:251]
    v_cvt_pk_bf16_f32 v38, v108, v109
    v_cvt_pk_bf16_f32 v39, v110, v111
    ds_write_b128 v12, v[36:39] offset:17408
    v_mfma_f32_16x16x32_bf16 v[96:99], a[16:19], v[48:51], v[96:99]
    v_fma_f32 v136, v136, v24, v16
    v_fma_f32 v137, v137, v25, v17
    s_add_u32 m0, s71, 0x23000
    s_add_u32 s58, s19, 0x120000
    buffer_load_dwordx4 v6, s[40:43], s58 offen offset:0 lds
    buffer_load_dwordx4 v6, s[40:43], s58 offen offset:1024 lds
    buffer_load_dwordx4 v6, s[40:43], s58 offen offset:2048 lds
    ds_read_b128 v[48:51], v56 offset:8192
    s_waitcnt lgkmcnt(4)
    v_mfma_f32_16x16x32_bf16 v[232:235], a[80:83], v[52:55], v[232:235]
    v_mfma_f32_16x16x32_bf16 v[252:255], v[52:55], a[144:147], v[252:255]
    v_fma_f32 v138, v138, v26, v18
    v_mfma_f32_16x16x32_bf16 v[100:103], a[16:19], v[52:55], v[100:103]
    v_fma_f32 v139, v139, v27, v19
    v_fma_f32 v140, v140, v28, v20
    ds_read_b128 v[52:55], v56 offset:24576
    s_waitcnt lgkmcnt(4)
    v_mfma_f32_16x16x32_bf16 v[236:239], a[80:83], v[40:43], v[236:239]
    v_fma_f32 v141, v141, v29, v21
    v_fma_f32 v142, v142, v30, v22
    v_mfma_f32_16x16x32_bf16 v[64:67], v[40:43], a[144:147], v[64:67]
    v_fma_f32 v143, v143, v31, v23
    v_cvt_pk_bf16_f32 v32, v136, v137
    v_mfma_f32_16x16x32_bf16 v[128:131], a[16:19], v[40:43], v[128:131]
    v_cvt_pk_bf16_f32 v33, v138, v139
    v_cvt_pk_bf16_f32 v34, v140, v141
    ds_read_b128 v[40:43], v56 offset:40960
    s_waitcnt lgkmcnt(4)
    v_mfma_f32_16x16x32_bf16 v[240:243], a[80:83], v[44:47], v[240:243]
    v_cvt_pk_bf16_f32 v35, v142, v143
    ds_write_b128 v12, v[32:35] offset:33792
    s_mov_b32 s28, s20
    s_and_b32 s29, s21, 0xffff
    s_mov_b32 s30, 0x80000
    s_mov_b32 s31, 0x00020000
    v_lshlrev_b32 v58, 7, v1
    s_and_b32 s58, s0, 31
    s_lshl_b32 s58, s58, 14
    s_lshl_b32 s59, s54, 13
    s_add_u32 s58, s58, s59
    s_mov_b32 m0, 161792
    s_xor_b32 s59, s54, s55
    s_cmp_eq_u32 s59, 1
    s_cselect_b64 exec, -1, 0
    buffer_load_dword v58, s[28:31], s58 offen lds
    s_mov_b64 exec, -1
    v_mfma_f32_16x16x32_bf16 v[68:71], v[44:47], a[144:147], v[68:71]
    v_mfma_f32_16x16x32_bf16 v[132:135], a[16:19], v[44:47], v[132:135]
    v_fma_f32 v168, v168, v24, v16
    ds_read_b128 v[44:47], v57 offset:8192
    s_waitcnt lgkmcnt(4)
    v_mfma_f32_16x16x32_bf16 v[224:227], a[96:99], v[48:51], v[224:227]
    v_fma_f32 v169, v169, v25, v17
    v_fma_f32 v170, v170, v26, v18
    v_mfma_f32_16x16x32_bf16 v[244:247], v[48:51], a[160:163], v[244:247]
    v_fma_f32 v171, v171, v27, v19
    v_fma_f32 v172, v172, v28, v20
    v_lshrrev_b32 v58, 3, v1
    s_sub_u32 s59, s72, 128
    v_mul_lo_u32 v58, v58, s59
    v_add_u32 v58, v4, v58
    s_lshl_b32 s72, s72, 3
    ds_read_b128 v[48:51], v57 offset:24576
    s_waitcnt lgkmcnt(4)
    v_mfma_f32_16x16x32_bf16 v[228:231], a[96:99], v[52:55], v[228:231]
    v_mfma_f32_16x16x32_bf16 v[248:251], v[52:55], a[160:163], v[248:251]
    v_fma_f32 v173, v173, v29, v21
    v_mfma_f32_16x16x32_bf16 v[96:99], a[32:35], v[52:55], v[96:99]
    v_fma_f32 v174, v174, v30, v22
    v_fma_f32 v175, v175, v31, v23
    ds_read_b128 v[52:55], v56 offset:12288
    s_waitcnt lgkmcnt(4)
    v_mfma_f32_16x16x32_bf16 v[232:235], a[96:99], v[40:43], v[232:235]
    v_cvt_pk_bf16_f32 v36, v168, v169
    v_cvt_pk_bf16_f32 v37, v170, v171
    v_mfma_f32_16x16x32_bf16 v[252:255], v[40:43], a[160:163], v[252:255]
    v_cvt_pk_bf16_f32 v38, v172, v173
    v_cvt_pk_bf16_f32 v39, v174, v175
    ds_write_b128 v13, v[36:39] offset:1024
    v_mfma_f32_16x16x32_bf16 v[100:103], a[32:35], v[40:43], v[100:103]
    v_fma_f32 v200, v200, v24, v16
    v_fma_f32 v201, v201, v25, v17
    ds_read_b128 v[40:43], v56 offset:28672
    s_waitcnt lgkmcnt(4)
    v_mfma_f32_16x16x32_bf16 v[236:239], a[96:99], v[44:47], v[236:239]
    v_fma_f32 v202, v202, v26, v18
    v_fma_f32 v203, v203, v27, v19
    v_mfma_f32_16x16x32_bf16 v[64:67], v[44:47], a[160:163], v[64:67]
    v_fma_f32 v204, v204, v28, v20
    v_fma_f32 v205, v205, v29, v21
    buffer_load_dwordx4 a[192:195], v58, s[44:47], s73 offen
    s_add_u32 s73, s73, s72
    v_mfma_f32_16x16x32_bf16 v[128:131], a[32:35], v[44:47], v[128:131]
    ds_read_b128 v[44:47], v56 offset:45056
    s_waitcnt lgkmcnt(4)
    v_mfma_f32_16x16x32_bf16 v[240:243], a[96:99], v[48:51], v[240:243]
    v_fma_f32 v206, v206, v30, v22
    v_mfma_f32_16x16x32_bf16 v[68:71], v[48:51], a[160:163], v[68:71]
    v_fma_f32 v207, v207, v31, v23
    v_cvt_pk_bf16_f32 v32, v200, v201
    v_mfma_f32_16x16x32_bf16 v[132:135], a[32:35], v[48:51], v[132:135]
    v_cvt_pk_bf16_f32 v33, v202, v203
    v_cvt_pk_bf16_f32 v34, v204, v205
    ds_read_b128 v[48:51], v57 offset:12288
    s_waitcnt lgkmcnt(4)
    v_mfma_f32_16x16x32_bf16 v[224:227], a[112:115], v[52:55], v[224:227]
    v_cvt_pk_bf16_f32 v35, v206, v207
    ds_write_b128 v13, v[32:35] offset:17408
    v_mfma_f32_16x16x32_bf16 v[244:247], v[52:55], a[176:179], v[244:247]
    s_waitcnt lgkmcnt(0)
    s_barrier
    ds_read_b128 v[16:19], v5 offset:256
    ds_read_b128 v[52:55], v57 offset:28672
    v_mfma_f32_16x16x32_bf16 v[228:231], a[112:115], v[40:43], v[228:231]
    ds_read_b128 v[20:23], v5 offset:272
    ds_read_b128 v[24:27], v5 offset:2304
    ds_read_b128 v[28:31], v5 offset:2320
    v_mfma_f32_16x16x32_bf16 v[248:251], v[40:43], a[176:179], v[248:251]
    s_waitcnt lgkmcnt(1)
    v_fma_f32 v80, v80, v24, v16
    v_fma_f32 v81, v81, v25, v17
    buffer_load_dwordx4 a[196:199], v58, s[44:47], s73 offen
    s_add_u32 s73, s73, s72
    v_mfma_f32_16x16x32_bf16 v[96:99], a[48:51], v[40:43], v[96:99]
    ds_read_b128 v[40:43], v56 offset:1024
    v_mfma_f32_16x16x32_bf16 v[232:235], a[112:115], v[44:47], v[232:235]
    v_fma_f32 v82, v82, v26, v18
    v_mfma_f32_16x16x32_bf16 v[252:255], v[44:47], a[176:179], v[252:255]
    v_fma_f32 v83, v83, v27, v19
    s_waitcnt lgkmcnt(1)
    v_fma_f32 v84, v84, v28, v20
    v_mfma_f32_16x16x32_bf16 v[100:103], a[48:51], v[44:47], v[100:103]
    v_fma_f32 v85, v85, v29, v21
    v_fma_f32 v86, v86, v30, v22
    ds_read_b128 v[44:47], v56 offset:17408
    v_mfma_f32_16x16x32_bf16 v[236:239], a[112:115], v[48:51], v[236:239]
    v_fma_f32 v87, v87, v31, v23
    v_cvt_pk_bf16_f32 v32, v80, v81
    v_mfma_f32_16x16x32_bf16 v[64:67], v[48:51], a[176:179], v[64:67]
    v_cvt_pk_bf16_f32 v33, v82, v83
    v_cvt_pk_bf16_f32 v34, v84, v85
    v_mfma_f32_16x16x32_bf16 v[128:131], a[48:51], v[48:51], v[128:131]
    v_cvt_pk_bf16_f32 v35, v86, v87
    ds_write_b128 v12, v[32:35] offset:2048
    v_fma_f32 v112, v112, v24, v16
    ds_read_b128 v[48:51], v56 offset:33792
    v_mfma_f32_16x16x32_bf16 v[240:243], a[112:115], v[52:55], v[240:243]
    v_fma_f32 v113, v113, v25, v17
    v_fma_f32 v114, v114, v26, v18
    buffer_load_dwordx4 a[200:203], v58, s[44:47], s73 offen
    s_add_u32 s73, s73, s72
    v_mfma_f32_16x16x32_bf16 v[68:71], v[52:55], a[176:179], v[68:71]
    v_mfma_f32_16x16x32_bf16 v[132:135], a[48:51], v[52:55], v[132:135]
    v_fma_f32 v115, v115, v27, v19
    ds_read_b128 v[52:55], v57 offset:1024
    s_waitcnt lgkmcnt(4)
    v_mfma_f32_16x16x32_bf16 v[224:227], a[68:71], v[40:43], v[224:227]
    v_fma_f32 v116, v116, v28, v20
    v_fma_f32 v117, v117, v29, v21
    v_mfma_f32_16x16x32_bf16 v[244:247], v[40:43], a[132:135], v[244:247]
    v_fma_f32 v118, v118, v30, v22
    v_fma_f32 v119, v119, v31, v23
    ds_read_b128 v[40:43], v57 offset:17408
    s_waitcnt lgkmcnt(4)
    v_mfma_f32_16x16x32_bf16 v[228:231], a[68:71], v[44:47], v[228:231]
    v_cvt_pk_bf16_f32 v36, v112, v113
    v_cvt_pk_bf16_f32 v37, v114, v115
    v_mfma_f32_16x16x32_bf16 v[248:251], v[44:47], a[132:135], v[248:251]
    v_cvt_pk_bf16_f32 v38, v116, v117
    v_cvt_pk_bf16_f32 v39, v118, v119
    v_mfma_f32_16x16x32_bf16 v[96:99], a[4:7], v[44:47], v[96:99]
    ds_write_b128 v12, v[36:39] offset:18432
    v_fma_f32 v144, v144, v24, v16
    ds_read_b128 v[44:47], v56 offset:5120
    s_waitcnt lgkmcnt(4)
    v_mfma_f32_16x16x32_bf16 v[232:235], a[68:71], v[48:51], v[232:235]
    v_fma_f32 v145, v145, v25, v17
    v_fma_f32 v146, v146, v26, v18
    buffer_load_dwordx4 a[204:207], v58, s[44:47], s73 offen
    v_mfma_f32_16x16x32_bf16 v[252:255], v[48:51], a[132:135], v[252:255]
    v_mfma_f32_16x16x32_bf16 v[100:103], a[4:7], v[48:51], v[100:103]
    v_fma_f32 v147, v147, v27, v19
    ds_read_b128 v[48:51], v56 offset:21504
    s_waitcnt lgkmcnt(4)
    v_mfma_f32_16x16x32_bf16 v[236:239], a[68:71], v[52:55], v[236:239]
    v_fma_f32 v148, v148, v28, v20
    v_fma_f32 v149, v149, v29, v21
    v_mfma_f32_16x16x32_bf16 v[64:67], v[52:55], a[132:135], v[64:67]
    v_fma_f32 v150, v150, v30, v22
    v_fma_f32 v151, v151, v31, v23
    v_lshlrev_b32 v58, 7, v1
    s_lshl_b32 s58, s52, 12
    s_lshl_b32 s59, s3, 17
    s_add_u32 s58, s58, s59
    s_lshl_b32 s59, s53, 9
    s_add_u32 s58, s58, s59
    s_add_u32 s58, s58, 0x100000
    s_mov_b32 m0, 161792
    s_and_b32 exec_lo, s34, 15
    s_and_b32 exec_hi, s34, 0
    buffer_load_dword v58, s[4:7], s58 offen sc1 lds
    s_mov_b64 exec, -1
    v_mfma_f32_16x16x32_bf16 v[128:131], a[4:7], v[52:55], v[128:131]
    ds_read_b128 v[52:55], v56 offset:37888
    s_waitcnt lgkmcnt(4)
    v_mfma_f32_16x16x32_bf16 v[240:243], a[68:71], v[40:43], v[240:243]
    v_cvt_pk_bf16_f32 v32, v144, v145
    v_mfma_f32_16x16x32_bf16 v[68:71], v[40:43], a[132:135], v[68:71]
    v_cvt_pk_bf16_f32 v33, v146, v147
    v_cvt_pk_bf16_f32 v34, v148, v149
    v_mfma_f32_16x16x32_bf16 v[132:135], a[4:7], v[40:43], v[132:135]
    v_cvt_pk_bf16_f32 v35, v150, v151
    ds_write_b128 v12, v[32:35] offset:34816
    v_fma_f32 v176, v176, v24, v16
    s_and_b32 s58, s0, 31
    s_lshl_b32 s58, s58, 4
    v_add_u32 v58, s58, v2
    v_mul_u32_u24 v58, 6144, v58
    v_lshl_add_u32 v58, v3, 10, v58
    s_lshr_b32 s58, s0, 5
    s_lshl_b32 s58, s58, 7
    s_add_u32 s58, s58, 2048
    s_mov_b32 m0, 161792
    s_cmp_eq_u32 s3, 0
    s_cselect_b32 exec_lo, -1, 0
    s_cselect_b32 exec_hi, -1, 0
    buffer_load_dword v58, s[12:15], s58 offen lds
    s_mov_b64 exec, -1
    ds_read_b128 v[40:43], v57 offset:5120
    s_waitcnt lgkmcnt(4)
    v_mfma_f32_16x16x32_bf16 v[224:227], a[84:87], v[44:47], v[224:227]
    v_mfma_f32_16x16x32_bf16 v[244:247], v[44:47], a[148:151], v[244:247]
    v_fma_f32 v177, v177, v25, v17
    ds_read_b128 v[44:47], v57 offset:21504
    s_waitcnt lgkmcnt(4)
    v_mfma_f32_16x16x32_bf16 v[228:231], a[84:87], v[48:51], v[228:231]
    v_fma_f32 v178, v178, v26, v18
    v_fma_f32 v179, v179, v27, v19
    v_mfma_f32_16x16x32_bf16 v[248:251], v[48:51], a[148:151], v[248:251]
    v_fma_f32 v180, v180, v28, v20
    v_fma_f32 v181, v181, v29, v21
    v_mfma_f32_16x16x32_bf16 v[96:99], a[20:23], v[48:51], v[96:99]
    v_fma_f32 v182, v182, v30, v22
    v_fma_f32 v183, v183, v31, v23
    ds_read_b128 v[48:51], v56 offset:9216
    s_waitcnt lgkmcnt(4)
    v_mfma_f32_16x16x32_bf16 v[232:235], a[84:87], v[52:55], v[232:235]
    v_cvt_pk_bf16_f32 v36, v176, v177
    v_cvt_pk_bf16_f32 v37, v178, v179
    v_mfma_f32_16x16x32_bf16 v[252:255], v[52:55], a[148:151], v[252:255]
    v_cvt_pk_bf16_f32 v38, v180, v181
    v_cvt_pk_bf16_f32 v39, v182, v183
    v_mfma_f32_16x16x32_bf16 v[100:103], a[20:23], v[52:55], v[100:103]
    ds_write_b128 v13, v[36:39] offset:2048
    v_fma_f32 v208, v208, v24, v16
    ds_read_b128 v[52:55], v56 offset:25600
    s_waitcnt lgkmcnt(4)
    v_mfma_f32_16x16x32_bf16 v[236:239], a[84:87], v[40:43], v[236:239]
    v_fma_f32 v209, v209, v25, v17
    v_fma_f32 v210, v210, v26, v18
    v_mfma_f32_16x16x32_bf16 v[64:67], v[40:43], a[148:151], v[64:67]
    v_fma_f32 v211, v211, v27, v19
    v_fma_f32 v212, v212, v28, v20
    v_mfma_f32_16x16x32_bf16 v[128:131], a[20:23], v[40:43], v[128:131]
    v_fma_f32 v213, v213, v29, v21
    v_fma_f32 v214, v214, v30, v22
    ds_read_b128 v[40:43], v56 offset:41984
    s_waitcnt lgkmcnt(4)
    v_mfma_f32_16x16x32_bf16 v[240:243], a[84:87], v[44:47], v[240:243]
    v_fma_f32 v215, v215, v31, v23
    v_cvt_pk_bf16_f32 v32, v208, v209
    v_mfma_f32_16x16x32_bf16 v[68:71], v[44:47], a[148:151], v[68:71]
    v_cvt_pk_bf16_f32 v33, v210, v211
    v_cvt_pk_bf16_f32 v34, v212, v213
    v_mfma_f32_16x16x32_bf16 v[132:135], a[20:23], v[44:47], v[132:135]
    v_cvt_pk_bf16_f32 v35, v214, v215
    ds_write_b128 v13, v[32:35] offset:18432
    ds_read_b128 v[16:19], v5 offset:384
    ds_read_b128 v[20:23], v5 offset:400
    ds_read_b128 v[44:47], v57 offset:9216
    s_waitcnt lgkmcnt(7)
    v_mfma_f32_16x16x32_bf16 v[224:227], a[100:103], v[48:51], v[224:227]
    ds_read_b128 v[24:27], v5 offset:2432
    ds_read_b128 v[28:31], v5 offset:2448
    s_waitcnt lgkmcnt(1)
    v_fma_f32 v88, v88, v24, v16
    v_mfma_f32_16x16x32_bf16 v[244:247], v[48:51], a[164:167], v[244:247]
    v_fma_f32 v89, v89, v25, v17
    v_fma_f32 v90, v90, v26, v18
    ds_read_b128 v[48:51], v57 offset:25600
    v_mfma_f32_16x16x32_bf16 v[228:231], a[100:103], v[52:55], v[228:231]
    v_fma_f32 v91, v91, v27, v19
    s_waitcnt lgkmcnt(1)
    v_fma_f32 v92, v92, v28, v20
    v_mfma_f32_16x16x32_bf16 v[248:251], v[52:55], a[164:167], v[248:251]
    v_fma_f32 v93, v93, v29, v21
    v_fma_f32 v94, v94, v30, v22
    v_mfma_f32_16x16x32_bf16 v[96:99], a[36:39], v[52:55], v[96:99]
    v_fma_f32 v95, v95, v31, v23
    v_cvt_pk_bf16_f32 v32, v88, v89
    ds_read_b128 v[52:55], v56 offset:13312
    v_mfma_f32_16x16x32_bf16 v[232:235], a[100:103], v[40:43], v[232:235]
    v_cvt_pk_bf16_f32 v33, v90, v91
    v_cvt_pk_bf16_f32 v34, v92, v93
    v_mfma_f32_16x16x32_bf16 v[252:255], v[40:43], a[164:167], v[252:255]
    v_cvt_pk_bf16_f32 v35, v94, v95
    ds_write_b128 v12, v[32:35] offset:3072
    v_mfma_f32_16x16x32_bf16 v[100:103], a[36:39], v[40:43], v[100:103]
    v_fma_f32 v120, v120, v24, v16
    v_fma_f32 v121, v121, v25, v17
    ds_read_b128 v[40:43], v56 offset:29696
    v_mfma_f32_16x16x32_bf16 v[236:239], a[100:103], v[44:47], v[236:239]
    v_fma_f32 v122, v122, v26, v18
    v_fma_f32 v123, v123, v27, v19
    v_mfma_f32_16x16x32_bf16 v[64:67], v[44:47], a[164:167], v[64:67]
    v_fma_f32 v124, v124, v28, v20
    v_fma_f32 v125, v125, v29, v21
    v_mfma_f32_16x16x32_bf16 v[128:131], a[36:39], v[44:47], v[128:131]
    v_fma_f32 v126, v126, v30, v22
    v_fma_f32 v127, v127, v31, v23
    ds_read_b128 v[44:47], v56 offset:46080
    s_waitcnt lgkmcnt(4)
    v_mfma_f32_16x16x32_bf16 v[240:243], a[100:103], v[48:51], v[240:243]
    v_cvt_pk_bf16_f32 v36, v120, v121
    v_cvt_pk_bf16_f32 v37, v122, v123
    v_mfma_f32_16x16x32_bf16 v[68:71], v[48:51], a[164:167], v[68:71]
    v_cvt_pk_bf16_f32 v38, v124, v125
    v_cvt_pk_bf16_f32 v39, v126, v127
    ds_write_b128 v12, v[36:39] offset:19456
    v_mfma_f32_16x16x32_bf16 v[132:135], a[36:39], v[48:51], v[132:135]
    v_fma_f32 v152, v152, v24, v16
    v_fma_f32 v153, v153, v25, v17
    ds_read_b128 v[48:51], v57 offset:13312
    s_waitcnt lgkmcnt(5)
    v_mfma_f32_16x16x32_bf16 v[224:227], a[116:119], v[52:55], v[224:227]
    v_fma_f32 v154, v154, v26, v18
    v_fma_f32 v155, v155, v27, v19
    v_mfma_f32_16x16x32_bf16 v[244:247], v[52:55], a[180:183], v[244:247]
    v_fma_f32 v156, v156, v28, v20
    v_fma_f32 v157, v157, v29, v21
    s_lshr_b32 s58, s0, 5
    s_and_b32 s59, s0, 31
    s_lshr_b32 s60, s59, 2
    s_lshl_b32 s60, s60, 3
    s_add_u32 s60, s60, s58
    s_lshl_b32 s60, s60, 2
    s_and_b32 s58, s59, 3
    s_add_u32 s78, s60, s58
    s_sub_u32 s59, s59, 8
    s_cmp_lt_u32 s59, 16
    s_cselect_b32 s79, 2, 0
    s_cselect_b32 s78, s78, 0
    s_cselect_b32 s14, s14, 0
    s_lshl_b32 s22, s78, 5
    ds_read_b128 v[52:55], v57 offset:29696
    s_waitcnt lgkmcnt(4)
    v_mfma_f32_16x16x32_bf16 v[228:231], a[116:119], v[40:43], v[228:231]
    v_mfma_f32_16x16x32_bf16 v[248:251], v[40:43], a[180:183], v[248:251]
    v_fma_f32 v158, v158, v30, v22
    v_mfma_f32_16x16x32_bf16 v[96:99], a[52:55], v[40:43], v[96:99]
    v_fma_f32 v159, v159, v31, v23
    v_cvt_pk_bf16_f32 v32, v152, v153
    v_cvt_pk_bf16_f32 v33, v154, v155
    v_cvt_pk_bf16_f32 v34, v156, v157
    v_cvt_pk_bf16_f32 v35, v158, v159
    ds_write_b128 v12, v[32:35] offset:35840
    v_fma_f32 v184, v184, v24, v16
    v_fma_f32 v185, v185, v25, v17
    v_fma_f32 v186, v186, v26, v18
    v_fma_f32 v187, v187, v27, v19
    v_fma_f32 v188, v188, v28, v20
    v_fma_f32 v189, v189, v29, v21
    v_fma_f32 v190, v190, v30, v22
    v_fma_f32 v191, v191, v31, v23
    v_cvt_pk_bf16_f32 v36, v184, v185
    v_cvt_pk_bf16_f32 v37, v186, v187
    v_cvt_pk_bf16_f32 v38, v188, v189
    v_cvt_pk_bf16_f32 v39, v190, v191
    ds_write_b128 v13, v[36:39] offset:3072
    v_fma_f32 v216, v216, v24, v16
    v_fma_f32 v217, v217, v25, v17
    v_fma_f32 v218, v218, v26, v18
    v_fma_f32 v219, v219, v27, v19
    v_fma_f32 v220, v220, v28, v20
    v_fma_f32 v221, v221, v29, v21
    v_fma_f32 v222, v222, v30, v22
    v_fma_f32 v223, v223, v31, v23
    v_cvt_pk_bf16_f32 v32, v216, v217
    v_cvt_pk_bf16_f32 v33, v218, v219
    v_cvt_pk_bf16_f32 v34, v220, v221
    v_cvt_pk_bf16_f32 v35, v222, v223
    ds_write_b128 v13, v[32:35] offset:19456
    s_waitcnt vmcnt(19)
    s_waitcnt lgkmcnt(0)
    s_barrier
    ds_read_b64_tr_b16 a[104:105], v14 offset:17408
    ds_read_b64_tr_b16 a[106:107], v14 offset:17920
    ds_read_b64_tr_b16 a[168:169], v14 offset:18432
    ds_read_b64_tr_b16 a[170:171], v14 offset:18944
    ds_read_b64_tr_b16 a[40:41], v14 offset:16384
    ds_read_b64_tr_b16 a[42:43], v14 offset:16896
    ds_read_b64_tr_b16 a[120:121], v14 offset:29696
    ds_read_b64_tr_b16 a[122:123], v14 offset:30208
    ds_read_b64_tr_b16 a[184:185], v14 offset:30720
    ds_read_b64_tr_b16 a[186:187], v14 offset:31232
    ds_read_b64_tr_b16 a[56:57], v14 offset:28672
    ds_read_b64_tr_b16 a[58:59], v14 offset:29184
    s_waitcnt vmcnt(13)
    s_waitcnt lgkmcnt(0)
    s_barrier
    ds_read_b128 v[40:43], v56 offset:2048
    v_mfma_f32_16x16x32_bf16 v[232:235], a[116:119], v[44:47], v[232:235]
    ds_read_b64_tr_b16 a[76:77], v14 offset:41984
    ds_read_b64_tr_b16 a[78:79], v14 offset:42496
    ds_read_b64_tr_b16 a[140:141], v14 offset:43008
    ds_read_b64_tr_b16 a[142:143], v14 offset:43520
    v_mfma_f32_16x16x32_bf16 v[252:255], v[44:47], a[180:183], v[252:255]
    ds_read_b64_tr_b16 a[12:13], v14 offset:40960
    ds_read_b64_tr_b16 a[14:15], v14 offset:41472
    ds_read_b64_tr_b16 a[92:93], v14 offset:54272
    ds_read_b64_tr_b16 a[94:95], v14 offset:54784
    v_mfma_f32_16x16x32_bf16 v[100:103], a[52:55], v[44:47], v[100:103]
    ds_read_b64_tr_b16 a[156:157], v14 offset:55296
    ds_read_b64_tr_b16 a[158:159], v14 offset:55808
    ds_read_b64_tr_b16 a[28:29], v14 offset:53248
    ds_read_b64_tr_b16 a[30:31], v14 offset:53760
    ds_read_b128 v[44:47], v56 offset:6144
    v_mfma_f32_16x16x32_bf16 v[236:239], a[116:119], v[48:51], v[236:239]
    s_waitcnt vmcnt(7)
    s_waitcnt lgkmcnt(0)
    s_barrier
    v_mfma_f32_16x16x32_bf16 v[64:67], v[48:51], a[180:183], v[64:67]
    ds_read_b64_tr_b16 a[108:109], v15 offset:1024
    ds_read_b64_tr_b16 a[110:111], v15 offset:1536
    ds_read_b64_tr_b16 a[172:173], v15 offset:2048
    ds_read_b64_tr_b16 a[174:175], v15 offset:2560
    v_mfma_f32_16x16x32_bf16 v[128:131], a[52:55], v[48:51], v[128:131]
    ds_read_b64_tr_b16 a[44:45], v15 offset:0
    ds_read_b64_tr_b16 a[46:47], v15 offset:512
    ds_read_b64_tr_b16 a[124:125], v15 offset:13312
    ds_read_b64_tr_b16 a[126:127], v15 offset:13824
    ds_read_b128 v[48:51], v56 offset:10240
    v_mfma_f32_16x16x32_bf16 v[240:243], a[116:119], v[52:55], v[240:243]
    ds_read_b64_tr_b16 a[188:189], v15 offset:14336
    ds_read_b64_tr_b16 a[190:191], v15 offset:14848
    ds_read_b64_tr_b16 a[60:61], v15 offset:12288
    ds_read_b64_tr_b16 a[62:63], v15 offset:12800
    v_mfma_f32_16x16x32_bf16 v[68:71], v[52:55], a[180:183], v[68:71]
    v_mov_b32 v172, 0x3f803f80
    v_mov_b32 v173, 0x3f803f80
    v_mov_b32 v174, 0x3f803f80
    v_mov_b32 v175, 0x3f803f80
    v_and_b32 v168, 1, v3
    v_lshlrev_b32 v168, 14, v168
    v_lshrrev_b32 v169, 1, v3
    v_lshl_add_u32 v169, v169, 4, v2
    v_lshl_add_u32 v168, v169, 4, v168
    s_lshl_b32 s70, s52, 16
    s_lshl_b32 s58, s53, 2
    s_add_u32 s58, s58, s3
    s_lshl_b32 s58, s58, 9
    s_add_u32 s70, s70, s58
    s_add_u32 s70, s70, 0x600000
    s_mov_b32 s71, 0x3eb8aa3b
    s_cmp_eq_u32 s52, 0
    s_cselect_b32 s58, 0xf149f2ca, 0
    v_mov_b32 v169, s58
    v_cndmask_b32 v170, v169, 0, s[92:93]
    v_cndmask_b32 v171, v169, 0, s[94:95]
    v_mfma_f32_16x16x32_bf16 v[132:135], a[52:55], v[52:55], v[132:135]
    ds_read_b128 v[52:55], v56 offset:14336
    v_mfma_f32_16x16x32_bf16 v[224:227], a[72:75], v[40:43], v[224:227]
    buffer_load_dwordx4 v[208:211], v62, s[12:15], s22 offen
    s_add_u32 s22, s22, 0xc0000
    v_mfma_f32_16x16x32_bf16 v[244:247], v[40:43], a[136:139], v[244:247]
    ds_read_b128 v[40:43], v56 offset:3072
    v_mfma_f32_16x16x32_bf16 v[224:227], a[88:91], v[44:47], v[224:227]
    v_mfma_f32_16x16x32_bf16 v[244:247], v[44:47], a[152:155], v[244:247]
    ds_read_b128 v[44:47], v56 offset:7168
    s_waitcnt lgkmcnt(7)
    v_mfma_f32_16x16x32_bf16 v[224:227], a[104:107], v[48:51], v[224:227]
    buffer_load_dwordx4 v[212:215], v62, s[12:15], s22 offen
    s_add_u32 s22, s22, 0xc0000
    v_mfma_f32_16x16x32_bf16 v[244:247], v[48:51], a[168:171], v[244:247]
    ds_read_b128 v[48:51], v56 offset:11264
    s_waitcnt lgkmcnt(3)
    v_mfma_f32_16x16x32_bf16 v[224:227], a[120:123], v[52:55], v[224:227]
    v_mfma_f32_16x16x32_bf16 v[244:247], v[52:55], a[184:187], v[244:247]
    ds_read_b128 v[52:55], v56 offset:15360
    s_waitcnt lgkmcnt(3)
    v_mfma_f32_16x16x32_bf16 v[224:227], a[76:79], v[40:43], v[224:227]
    buffer_load_dwordx4 v[216:219], v62, s[12:15], s22 offen
    s_add_u32 s22, s22, 0xc0000
    v_mfma_f32_16x16x32_bf16 v[244:247], v[40:43], a[140:143], v[244:247]
    ds_read_b128 v[40:43], v56 offset:18432
    s_waitcnt lgkmcnt(3)
    v_mfma_f32_16x16x32_bf16 v[224:227], a[92:95], v[44:47], v[224:227]
    v_mfma_f32_16x16x32_bf16 v[244:247], v[44:47], a[156:159], v[244:247]
    ds_read_b128 v[44:47], v56 offset:22528
    s_waitcnt lgkmcnt(3)
    v_mfma_f32_16x16x32_bf16 v[224:227], a[108:111], v[48:51], v[224:227]
    buffer_load_dwordx4 v[220:223], v62, s[12:15], s22 offen
    v_mfma_f32_16x16x32_bf16 v[244:247], v[48:51], a[172:175], v[244:247]
    ds_read_b128 v[48:51], v56 offset:26624
    s_waitcnt lgkmcnt(3)
    v_mfma_f32_16x16x32_bf16 v[224:227], a[124:127], v[52:55], v[224:227]
    v_mfma_f32_16x16x32_bf16 v[244:247], v[52:55], a[188:191], v[244:247]
    ds_read_b128 v[52:55], v56 offset:30720
    s_waitcnt lgkmcnt(3)
    v_mfma_f32_16x16x32_bf16 v[228:231], a[72:75], v[40:43], v[228:231]
    s_nop 3
    v_cvt_pk_bf16_f32 v136, v224, v225
    v_cvt_pk_bf16_f32 v137, v226, v227
    v_cvt_pk_bf16_f32 v146, v244, v245
    v_cvt_pk_bf16_f32 v147, v246, v247
    v_mfma_f32_16x16x32_bf16 v[248:251], v[40:43], a[136:139], v[248:251]
    s_waitcnt lgkmcnt(0)
    s_barrier
    v_bfe_u32 v92, v1, 3, 1
    v_lshlrev_b32 v92, 15, v92
    v_and_b32 v93, 7, v1
    v_lshl_add_u32 v92, v93, 7, v92
    s_lshl_b32 s58, s52, 16
    s_lshl_b32 s59, s54, 14
    s_add_u32 s58, s58, s59
    s_lshl_b32 s59, s53, 11
    s_add_u32 s58, s58, s59
    s_lshl_b32 s59, s55, 10
    s_add_u32 s58, s58, s59
    s_add_u32 s58, s58, 0x800000
    s_mov_b32 m0, 161792
    s_and_b32 exec_lo, s34, 0xffff
    s_and_b32 exec_hi, s34, 0
    buffer_load_dword v92, s[4:7], s58 offen sc1 lds
    s_mov_b64 exec, -1
    v_mfma_f32_16x16x32_bf16 v[96:99], a[8:11], v[40:43], v[96:99]
    ds_read_b128 v[40:43], v56 offset:19456
    v_mfma_f32_16x16x32_bf16 v[228:231], a[88:91], v[44:47], v[228:231]
    s_mov_b32 s40, s20
    s_and_b32 s41, s21, 0xffff
    s_mov_b32 s42, 0x80000
    s_mov_b32 s43, 0x00020000
    v_lshrrev_b32 v7, 3, v1
    v_mul_u32_u24 v7, 2048, v7
    v_sub_u32 v6, v6, v7
    s_lshl_b32 s16, s3, 13
    s_lshl_b32 s58, s53, 7
    s_add_u32 s16, s16, s58
    s_lshl_b32 s17, s3, 10
    s_add_u32 s17, s17, 81920
    v_mfma_f32_16x16x32_bf16 v[248:251], v[44:47], a[152:155], v[248:251]
    v_mfma_f32_16x16x32_bf16 v[96:99], a[24:27], v[44:47], v[96:99]
    ds_read_b128 v[44:47], v56 offset:23552
    v_mfma_f32_16x16x32_bf16 v[228:231], a[104:107], v[48:51], v[228:231]
    v_mfma_f32_16x16x32_bf16 v[248:251], v[48:51], a[168:171], v[248:251]
    v_mfma_f32_16x16x32_bf16 v[96:99], a[40:43], v[48:51], v[96:99]
    ds_read_b128 v[48:51], v56 offset:27648
    v_mfma_f32_16x16x32_bf16 v[228:231], a[120:123], v[52:55], v[228:231]
    v_mfma_f32_16x16x32_bf16 v[248:251], v[52:55], a[184:187], v[248:251]
    v_mfma_f32_16x16x32_bf16 v[96:99], a[56:59], v[52:55], v[96:99]
    ds_read_b128 v[52:55], v56 offset:31744
    s_waitcnt lgkmcnt(3)
    v_mfma_f32_16x16x32_bf16 v[228:231], a[76:79], v[40:43], v[228:231]
    v_mfma_f32_16x16x32_bf16 v[248:251], v[40:43], a[140:143], v[248:251]
    v_mfma_f32_16x16x32_bf16 v[96:99], a[12:15], v[40:43], v[96:99]
    ds_read_b128 v[40:43], v56 offset:34816
    s_waitcnt lgkmcnt(3)
    v_mfma_f32_16x16x32_bf16 v[228:231], a[92:95], v[44:47], v[228:231]
    v_mfma_f32_16x16x32_bf16 v[248:251], v[44:47], a[156:159], v[248:251]
    v_mfma_f32_16x16x32_bf16 v[96:99], a[28:31], v[44:47], v[96:99]
    ds_read_b128 v[44:47], v56 offset:38912
    s_waitcnt lgkmcnt(3)
    v_mfma_f32_16x16x32_bf16 v[228:231], a[108:111], v[48:51], v[228:231]
    v_mfma_f32_16x16x32_bf16 v[248:251], v[48:51], a[172:175], v[248:251]
    v_lshlrev_b32 v92, 7, v1
    s_lshl_b32 s58, s52, 13
    s_lshl_b32 s59, s53, 10
    s_add_u32 s58, s58, s59
    s_lshl_b32 s59, s3, 8
    s_add_u32 s58, s58, s59
    s_add_u32 s58, s58, 0x8000
    s_mov_b32 m0, 161792
    s_and_b32 exec_lo, s34, 3
    s_and_b32 exec_hi, s34, 0
    buffer_load_dword v92, s[4:7], s58 offen sc1 lds
    s_mov_b64 exec, -1
    v_mfma_f32_16x16x32_bf16 v[96:99], a[44:47], v[48:51], v[96:99]
    ds_read_b128 v[48:51], v56 offset:43008
    s_waitcnt lgkmcnt(3)
    v_mfma_f32_16x16x32_bf16 v[228:231], a[124:127], v[52:55], v[228:231]
    v_mfma_f32_16x16x32_bf16 v[248:251], v[52:55], a[188:191], v[248:251]
    v_mfma_f32_16x16x32_bf16 v[96:99], a[60:63], v[52:55], v[96:99]
    ds_read_b128 v[52:55], v56 offset:47104
    s_waitcnt lgkmcnt(3)
    v_mfma_f32_16x16x32_bf16 v[232:235], a[72:75], v[40:43], v[232:235]
    s_nop 2
    v_cvt_pk_bf16_f32 v138, v228, v229
    v_cvt_pk_bf16_f32 v139, v230, v231
    v_cvt_pk_bf16_f32 v156, v96, v97
    v_cvt_pk_bf16_f32 v157, v98, v99
    v_mfma_f32_16x16x32_bf16 v[252:255], v[40:43], a[136:139], v[252:255]
    s_nop 0
    v_mfma_f32_16x16x16_bf16 v[160:163], v[136:137], v[156:157], 0
    v_mfma_f32_16x16x16_bf16 v[164:167], v[138:139], v[156:157], 0
    v_mfma_f32_16x16x32_bf16 v[100:103], a[8:11], v[40:43], v[100:103]
    v_cvt_pk_bf16_f32 v148, v248, v249
    v_cvt_pk_bf16_f32 v149, v250, v251
    ds_read_b128 v[40:43], v56 offset:35840
    s_waitcnt lgkmcnt(3)
    v_mfma_f32_16x16x32_bf16 v[232:235], a[88:91], v[44:47], v[232:235]
    v_mfma_f32_16x16x32_bf16 v[252:255], v[44:47], a[152:155], v[252:255]
    s_waitcnt vmcnt(2)
    s_cmp_eq_u32 s79, 2
    s_cbranch_scc0 L_nolate
    v_lshrrev_b32 v116, 16, v8
    v_lshrrev_b32 v117, 16, v9
    v_lshrrev_b32 v118, 16, v10
    v_lshrrev_b32 v119, 16, v11
    v_dot2_f32_bf16 v108, v208, v116, 0
    v_dot2_f32_bf16 v109, v208, v8, 0
    v_dot2_f32_bf16 v110, v209, v116, 0
    v_dot2_f32_bf16 v111, v209, v8, 0
    v_dot2_f32_bf16 v112, v210, v116, 0
    v_dot2_f32_bf16 v113, v210, v8, 0
    v_dot2_f32_bf16 v114, v211, v116, 0
    v_dot2_f32_bf16 v115, v211, v8, 0
    v_dot2_f32_bf16 v108, v212, v117, v108
    v_dot2_f32_bf16 v109, v212, v9, v109
    v_dot2_f32_bf16 v110, v213, v117, v110
    v_dot2_f32_bf16 v111, v213, v9, v111
    v_dot2_f32_bf16 v112, v214, v117, v112
    v_dot2_f32_bf16 v113, v214, v9, v113
    v_dot2_f32_bf16 v114, v215, v117, v114
    v_dot2_f32_bf16 v115, v215, v9, v115
    v_dot2_f32_bf16 v108, v216, v118, v108
    v_dot2_f32_bf16 v109, v216, v10, v109
    v_dot2_f32_bf16 v110, v217, v118, v110
    v_dot2_f32_bf16 v111, v217, v10, v111
    v_dot2_f32_bf16 v112, v218, v118, v112
    v_dot2_f32_bf16 v113, v218, v10, v113
    v_dot2_f32_bf16 v114, v219, v118, v114
    v_dot2_f32_bf16 v115, v219, v10, v115
    v_dot2_f32_bf16 v108, v220, v119, v108
    v_dot2_f32_bf16 v109, v220, v11, v109
    v_dot2_f32_bf16 v110, v221, v119, v110
    v_dot2_f32_bf16 v111, v221, v11, v111
    v_dot2_f32_bf16 v112, v222, v119, v112
    v_dot2_f32_bf16 v113, v222, v11, v113
    v_dot2_f32_bf16 v114, v223, v119, v114
    v_dot2_f32_bf16 v115, v223, v11, v115
    v_add_f32_dpp v108, v108, v108 row_shr:2 row_mask:0xf bank_mask:0xf bound_ctrl:0
    v_add_f32_dpp v109, v109, v109 row_shr:2 row_mask:0xf bank_mask:0xf bound_ctrl:0
    v_add_f32_dpp v110, v110, v110 row_shr:2 row_mask:0xf bank_mask:0xf bound_ctrl:0
    v_add_f32_dpp v111, v111, v111 row_shr:2 row_mask:0xf bank_mask:0xf bound_ctrl:0
    v_add_f32_dpp v112, v112, v112 row_shr:2 row_mask:0xf bank_mask:0xf bound_ctrl:0
    v_add_f32_dpp v113, v113, v113 row_shr:2 row_mask:0xf bank_mask:0xf bound_ctrl:0
    v_add_f32_dpp v114, v114, v114 row_shr:2 row_mask:0xf bank_mask:0xf bound_ctrl:0
    v_add_f32_dpp v115, v115, v115 row_shr:2 row_mask:0xf bank_mask:0xf bound_ctrl:0
    v_add_f32_dpp v108, v108, v108 row_shr:4 row_mask:0xf bank_mask:0xf bound_ctrl:0
    v_add_f32_dpp v109, v109, v109 row_shr:4 row_mask:0xf bank_mask:0xf bound_ctrl:0
    v_add_f32_dpp v110, v110, v110 row_shr:4 row_mask:0xf bank_mask:0xf bound_ctrl:0
    v_add_f32_dpp v111, v111, v111 row_shr:4 row_mask:0xf bank_mask:0xf bound_ctrl:0
    v_add_f32_dpp v112, v112, v112 row_shr:4 row_mask:0xf bank_mask:0xf bound_ctrl:0
    v_add_f32_dpp v113, v113, v113 row_shr:4 row_mask:0xf bank_mask:0xf bound_ctrl:0
    v_add_f32_dpp v114, v114, v114 row_shr:4 row_mask:0xf bank_mask:0xf bound_ctrl:0
    v_add_f32_dpp v115, v115, v115 row_shr:4 row_mask:0xf bank_mask:0xf bound_ctrl:0
    v_add_f32_dpp v108, v108, v108 row_shr:8 row_mask:0xf bank_mask:0xf bound_ctrl:0
    v_add_f32_dpp v109, v109, v109 row_shr:8 row_mask:0xf bank_mask:0xf bound_ctrl:0
    v_add_f32_dpp v110, v110, v110 row_shr:8 row_mask:0xf bank_mask:0xf bound_ctrl:0
    v_add_f32_dpp v111, v111, v111 row_shr:8 row_mask:0xf bank_mask:0xf bound_ctrl:0
    v_add_f32_dpp v112, v112, v112 row_shr:8 row_mask:0xf bank_mask:0xf bound_ctrl:0
    v_add_f32_dpp v113, v113, v113 row_shr:8 row_mask:0xf bank_mask:0xf bound_ctrl:0
    v_add_f32_dpp v114, v114, v114 row_shr:8 row_mask:0xf bank_mask:0xf bound_ctrl:0
    v_add_f32_dpp v115, v115, v115 row_shr:8 row_mask:0xf bank_mask:0xf bound_ctrl:0
    s_lshl_b32 s58, s3, 8
    s_add_u32 s58, s58, 159744
    v_lshl_add_u32 v104, v3, 6, s58
    v_and_b32 v105, 1, v1
    v_lshl_add_u32 v104, v105, 5, v104
    s_mov_b32 s58, 0xc000c000
    s_mov_b32 s59, 0xc000c000
    s_mov_b64 exec, s[58:59]
    ds_write_b128 v104, v[108:111]
    ds_write_b128 v104, v[112:115] offset:16
    s_mov_b64 exec, -1
    v_lshlrev_b32 v104, 2, v2
    v_lshl_add_u32 v104, v3, 8, v104
    v_add_u32 v104, 159744, v104
    s_lshr_b32 s58, s78, 5
    s_cmp_eq_u32 s58, 1
    s_cselect_b32 s59, 1.0, 0
    s_cmp_eq_u32 s58, 4
    s_cselect_b32 s59, 1.0, s59
    s_lshl_b32 s58, s78, 6
    s_add_u32 s58, s58, 0x4000
    s_cmp_eq_u32 s79, 2
    s_cselect_b32 s60, 0x5555, 0
    s_mov_b32 s61, 0
    v_lshlrev_b32 v105, 2, v2
    s_waitcnt lgkmcnt(0)
    s_barrier
    s_cmp_eq_u32 s3, 3
    s_cbranch_scc0 L_w3_6
    v_mov_b32 v119, s38
    ds_read2_b32 v[106:107], v104 offset0:0 offset1:16
    ds_read2_b32 v[110:111], v104 offset0:32 offset1:48
    s_waitcnt lgkmcnt(1)
    v_add_f32 v106, v106, v107
    s_waitcnt lgkmcnt(0)
    v_add_f32 v110, v110, v111
    v_add_f32 v106, v106, v110
    v_mov_b32 v107, v106
    s_nop 1
    v_permlane32_swap_b32 v107, v106
    v_add_f32 v106, v106, v107
    v_mov_b32 v107, v106
    s_nop 1
    v_permlane16_swap_b32 v107, v106
    v_add_f32 v106, v106, v107
    v_cvt_pk_bf16_f32 v106, v106, v106
    v_and_b32 v106, 0xffff0000, v106
    v_add_f32 v106, s59, v106
    s_nop 1
    v_mov_b32_dpp v107, v106 quad_perm:[1,0,3,2] row_mask:0xf bank_mask:0xf
    v_cvt_pk_bf16_f32 v118, v106, v107
    s_waitcnt lgkmcnt(0)
    s_nop 1
L_w3_6:
    s_and_b64 exec, s[60:61], s[100:101]
    buffer_store_dwordx2 v[118:119], v105, s[4:7], s58 offen sc1
    s_mov_b64 exec, -1
L_nolate:
    v_mfma_f32_16x16x32_bf16 v[100:103], a[24:27], v[44:47], v[100:103]
    ds_read_b128 v[44:47], v56 offset:39936
    s_waitcnt lgkmcnt(3)
    v_mfma_f32_16x16x32_bf16 v[232:235], a[104:107], v[48:51], v[232:235]
    v_mfma_f32_16x16x32_bf16 v[252:255], v[48:51], a[168:171], v[252:255]
    v_mfma_f32_16x16x32_bf16 v[100:103], a[40:43], v[48:51], v[100:103]
    ds_read_b128 v[48:51], v56 offset:44032
    s_waitcnt lgkmcnt(3)
    v_mfma_f32_16x16x32_bf16 v[232:235], a[120:123], v[52:55], v[232:235]
    v_mfma_f32_16x16x32_bf16 v[252:255], v[52:55], a[184:187], v[252:255]
    v_mfma_f32_16x16x32_bf16 v[100:103], a[56:59], v[52:55], v[100:103]
    ds_read_b128 v[52:55], v56 offset:48128
    s_waitcnt lgkmcnt(3)
    v_mfma_f32_16x16x32_bf16 v[232:235], a[76:79], v[40:43], v[232:235]
    v_mfma_f32_16x16x32_bf16 v[252:255], v[40:43], a[140:143], v[252:255]
    v_mfma_f32_16x16x32_bf16 v[100:103], a[12:15], v[40:43], v[100:103]
    s_lshl_b32 s58, s3, 14
    v_add_u32 v72, s58, v4
    ds_write_b128 v72, a[192:195] offset:0
    ds_write_b128 v72, a[196:199] offset:4096
    ds_write_b128 v72, a[200:203] offset:8192
    ds_write_b128 v72, a[204:207] offset:12288
    v_bfe_u32 v72, v1, 2, 2
    v_lshlrev_b32 v72, 7, v72
    v_lshl_add_u32 v72, v3, 12, v72
    v_add_u32 v72, s58, v72
    v_and_b32 v73, 3, v1
    v_mad_u32_u24 v72, v73, s76, v72
    s_cmp_eq_u32 s76, 8
    s_cselect_b32 s58, 32, 8
    s_add_u32 s59, s58, 64
    v_add_u32 v73, s58, v72
    v_add_u32 v74, 64, v72
    v_add_u32 v75, s59, v72
    ds_read_b128 v[40:43], v57 offset:2048
    s_waitcnt lgkmcnt(7)
    v_mfma_f32_16x16x32_bf16 v[232:235], a[92:95], v[44:47], v[232:235]
    v_mfma_f32_16x16x32_bf16 v[252:255], v[44:47], a[156:159], v[252:255]
    v_mfma_f32_16x16x32_bf16 v[100:103], a[28:31], v[44:47], v[100:103]
    ds_read_b128 v[44:47], v57 offset:6144
    s_waitcnt lgkmcnt(7)
    v_mfma_f32_16x16x32_bf16 v[232:235], a[108:111], v[48:51], v[232:235]
    v_mfma_f32_16x16x32_bf16 v[252:255], v[48:51], a[172:175], v[252:255]
    ds_read_b64_tr_b16 v[76:77], v72 offset:0
    ds_read_b64_tr_b16 v[78:79], v72 offset:512
    ds_read_b64_tr_b16 v[80:81], v73 offset:0
    ds_read_b64_tr_b16 v[82:83], v73 offset:512
    ds_read_b64_tr_b16 v[84:85], v74 offset:0
    ds_read_b64_tr_b16 v[86:87], v74 offset:512
    ds_read_b64_tr_b16 v[88:89], v75 offset:0
    ds_read_b64_tr_b16 v[90:91], v75 offset:512
    v_mfma_f32_16x16x32_bf16 v[100:103], a[44:47], v[48:51], v[100:103]
    ds_read_b128 v[48:51], v57 offset:10240
    s_waitcnt lgkmcnt(15)
    v_mfma_f32_16x16x32_bf16 v[232:235], a[124:127], v[52:55], v[232:235]
    v_mfma_f32_16x16x32_bf16 v[252:255], v[52:55], a[188:191], v[252:255]
    v_mfma_f32_16x16x32_bf16 v[100:103], a[60:63], v[52:55], v[100:103]
    ds_read_b128 v[52:55], v57 offset:14336
    s_waitcnt lgkmcnt(11)
    v_mfma_f32_16x16x32_bf16 v[236:239], a[72:75], v[40:43], v[236:239]
    s_waitcnt lgkmcnt(8)
    buffer_store_dwordx4 v[76:79], v4, s[4:7], s74 offen sc1
    s_nop 1
    s_add_u32 s74, s74, s75
    v_mfma_f32_16x16x32_bf16 v[64:67], v[40:43], a[136:139], v[64:67]
    s_waitcnt lgkmcnt(6)
    buffer_store_dwordx4 v[80:83], v4, s[4:7], s74 offen sc1
    s_nop 1
    s_add_u32 s74, s74, s75
    v_mfma_f32_16x16x32_bf16 v[128:131], a[8:11], v[40:43], v[128:131]
    s_waitcnt lgkmcnt(4)
    buffer_store_dwordx4 v[84:87], v4, s[4:7], s74 offen sc1
    s_nop 1
    s_add_u32 s74, s74, s75
    ds_read_b128 v[40:43], v57 offset:3072
    v_mfma_f32_16x16x32_bf16 v[236:239], a[88:91], v[44:47], v[236:239]
    s_waitcnt lgkmcnt(3)
    buffer_store_dwordx4 v[88:91], v4, s[4:7], s74 offen sc1
    v_mfma_f32_16x16x32_bf16 v[64:67], v[44:47], a[152:155], v[64:67]
    v_cvt_pk_bf16_f32 v140, v232, v233
    v_cndmask_b32 v177, v160, v161, s[90:91]
    v_mfma_f32_16x16x32_bf16 v[128:131], a[24:27], v[44:47], v[128:131]
    v_cvt_pk_bf16_f32 v141, v234, v235
    v_cndmask_b32 v179, v162, v163, s[90:91]
    ds_read_b128 v[44:47], v57 offset:7168
    s_waitcnt lgkmcnt(3)
    v_mfma_f32_16x16x32_bf16 v[236:239], a[104:107], v[48:51], v[236:239]
    v_cvt_pk_bf16_f32 v158, v100, v101
    v_cndmask_b32 v176, v164, v165, s[90:91]
    v_mfma_f32_16x16x32_bf16 v[64:67], v[48:51], a[168:171], v[64:67]
    v_cvt_pk_bf16_f32 v159, v102, v103
    v_cndmask_b32 v178, v166, v167, s[90:91]
    v_mfma_f32_16x16x32_bf16 v[128:131], a[40:43], v[48:51], v[128:131]
    v_mfma_f32_16x16x16_bf16 v[104:107], v[138:139], v[158:159], 0
    v_cndmask_b32 v180, v177, v176, s[92:93]
    ds_read_b128 v[48:51], v57 offset:11264
    s_waitcnt lgkmcnt(3)
    v_mfma_f32_16x16x32_bf16 v[236:239], a[120:123], v[52:55], v[236:239]
    v_mfma_f32_16x16x16_bf16 v[108:111], v[140:141], v[158:159], 0
    v_cndmask_b32 v181, v179, v178, s[94:95]
    v_mfma_f32_16x16x32_bf16 v[64:67], v[52:55], a[184:187], v[64:67]
    v_cvt_pk_bf16_f32 v150, v252, v253
    v_add_f32 v180, v180, v170
    v_mfma_f32_16x16x32_bf16 v[128:131], a[56:59], v[52:55], v[128:131]
    v_cvt_pk_bf16_f32 v151, v254, v255
    v_add_f32 v181, v181, v171
    ds_read_b128 v[52:55], v57 offset:15360
    s_waitcnt lgkmcnt(3)
    v_mfma_f32_16x16x32_bf16 v[236:239], a[76:79], v[40:43], v[236:239]
    v_mfma_f32_16x16x32_bf16 v[64:67], v[40:43], a[140:143], v[64:67]
    v_max_f32 v182, v180, v181
    v_mov_b32 v183, v182
    v_mfma_f32_16x16x32_bf16 v[128:131], a[12:15], v[40:43], v[128:131]
    v_cndmask_b32 v113, v104, v105, s[90:91]
    v_permlane32_swap_b32 v183, v182
    ds_read_b128 v[40:43], v57 offset:18432
    s_waitcnt lgkmcnt(3)
    v_mfma_f32_16x16x32_bf16 v[236:239], a[92:95], v[44:47], v[236:239]
    v_cndmask_b32 v115, v106, v107, s[90:91]
    v_mfma_f32_16x16x32_bf16 v[64:67], v[44:47], a[156:159], v[64:67]
    v_max_f32 v182, v182, v183
    v_cndmask_b32 v112, v108, v109, s[90:91]
    v_mfma_f32_16x16x32_bf16 v[128:131], a[28:31], v[44:47], v[128:131]
    v_mov_b32 v183, v182
    v_cndmask_b32 v114, v110, v111, s[90:91]
    ds_read_b128 v[44:47], v57 offset:22528
    s_waitcnt lgkmcnt(3)
    v_mfma_f32_16x16x32_bf16 v[236:239], a[108:111], v[48:51], v[236:239]
    v_permlane16_swap_b32 v183, v182
    v_mfma_f32_16x16x32_bf16 v[64:67], v[48:51], a[172:175], v[64:67]
    v_cndmask_b32 v92, v113, v112, s[92:93]
    v_max_f32 v182, v182, v183
    v_mfma_f32_16x16x32_bf16 v[128:131], a[44:47], v[48:51], v[128:131]
    v_cndmask_b32 v93, v115, v114, s[94:95]
    v_sub_f32 v180, v180, v182
    ds_read_b128 v[48:51], v57 offset:26624
    s_waitcnt lgkmcnt(3)
    v_mfma_f32_16x16x32_bf16 v[236:239], a[124:127], v[52:55], v[236:239]
    v_max_f32 v94, v92, v93
    v_sub_f32 v181, v181, v182
    v_mfma_f32_16x16x32_bf16 v[64:67], v[52:55], a[188:191], v[64:67]
    v_mov_b32 v95, v94
    v_mul_f32 v180, s71, v180
    v_mfma_f32_16x16x32_bf16 v[128:131], a[60:63], v[52:55], v[128:131]
    v_permlane32_swap_b32 v95, v94
    ds_read_b128 v[52:55], v57 offset:30720
    s_waitcnt lgkmcnt(3)
    v_mfma_f32_16x16x32_bf16 v[240:243], a[72:75], v[40:43], v[240:243]
    v_mul_f32 v181, s71, v181
    v_max_f32 v94, v94, v95
    v_mfma_f32_16x16x32_bf16 v[68:71], v[40:43], a[136:139], v[68:71]
    v_exp_f32 v180, v180
    v_mfma_f32_16x16x32_bf16 v[132:135], a[8:11], v[40:43], v[132:135]
    v_mov_b32 v95, v94
    v_exp_f32 v181, v181
    ds_read_b128 v[40:43], v57 offset:19456
    s_waitcnt lgkmcnt(3)
    v_mfma_f32_16x16x32_bf16 v[240:243], a[88:91], v[44:47], v[240:243]
    v_permlane16_swap_b32 v95, v94
    v_mfma_f32_16x16x32_bf16 v[68:71], v[44:47], a[152:155], v[68:71]
    v_cvt_pk_bf16_f32 v180, v180, v180
    v_mfma_f32_16x16x32_bf16 v[132:135], a[24:27], v[44:47], v[132:135]
    v_max_f32 v94, v94, v95
    v_cvt_pk_bf16_f32 v181, v181, v181
    ds_read_b128 v[44:47], v57 offset:23552
    s_waitcnt lgkmcnt(3)
    v_mfma_f32_16x16x32_bf16 v[240:243], a[104:107], v[48:51], v[240:243]
    v_sub_f32 v92, v92, v94
    v_and_b32 v184, v180, v61
    v_mfma_f32_16x16x32_bf16 v[68:71], v[48:51], a[168:171], v[68:71]
    v_sub_f32 v93, v93, v94
    v_and_b32 v185, v181, v59
    v_mfma_f32_16x16x32_bf16 v[132:135], a[40:43], v[48:51], v[132:135]
    v_mul_f32 v92, s71, v92
    v_and_b32 v186, v180, v60
    ds_read_b128 v[48:51], v57 offset:27648
    s_waitcnt lgkmcnt(3)
    v_mfma_f32_16x16x32_bf16 v[240:243], a[120:123], v[52:55], v[240:243]
    v_mul_f32 v93, s71, v93
    v_and_b32 v187, v181, v63
    v_mfma_f32_16x16x32_bf16 v[68:71], v[52:55], a[184:187], v[68:71]
    v_exp_f32 v92, v92
    v_mfma_f32_16x16x32_bf16 v[132:135], a[56:59], v[52:55], v[132:135]
    v_exp_f32 v93, v93
    ds_read_b128 v[52:55], v57 offset:31744
    s_waitcnt lgkmcnt(3)
    v_mfma_f32_16x16x32_bf16 v[240:243], a[76:79], v[40:43], v[240:243]
    v_mfma_f32_16x16x32_bf16 v[200:203], v[172:175], v[184:187], 0
    v_mfma_f32_16x16x32_bf16 v[68:71], v[40:43], a[140:143], v[68:71]
    v_cvt_pk_bf16_f32 v92, v92, v92
    v_mfma_f32_16x16x32_bf16 v[188:191], v[146:149], v[184:187], 0
    v_mfma_f32_16x16x32_bf16 v[132:135], a[12:15], v[40:43], v[132:135]
    v_cvt_pk_bf16_f32 v93, v93, v93
    s_waitcnt lgkmcnt(2)
    v_mfma_f32_16x16x32_bf16 v[240:243], a[92:95], v[44:47], v[240:243]
    v_and_b32 v116, v92, v61
    v_mfma_f32_16x16x32_bf16 v[68:71], v[44:47], a[156:159], v[68:71]
    v_rcp_f32 v200, v200
    v_mfma_f32_16x16x32_bf16 v[132:135], a[28:31], v[44:47], v[132:135]
    v_and_b32 v117, v93, v59
    v_mul_f32 v188, v188, v200
    s_waitcnt lgkmcnt(1)
    v_mfma_f32_16x16x32_bf16 v[240:243], a[108:111], v[48:51], v[240:243]
    v_and_b32 v118, v92, v60
    v_mul_f32 v189, v189, v200
    v_mfma_f32_16x16x32_bf16 v[68:71], v[48:51], a[172:175], v[68:71]
    v_and_b32 v119, v93, v63
    v_mul_f32 v190, v190, v200
    v_mfma_f32_16x16x32_bf16 v[132:135], a[44:47], v[48:51], v[132:135]
    v_mul_f32 v191, v191, v200
    s_waitcnt lgkmcnt(0)
    v_mfma_f32_16x16x32_bf16 v[240:243], a[124:127], v[52:55], v[240:243]
    v_mfma_f32_16x16x32_bf16 v[124:127], v[172:175], v[116:119], 0
    v_cvt_pk_bf16_f32 v204, v188, v189
    v_mfma_f32_16x16x32_bf16 v[68:71], v[52:55], a[188:191], v[68:71]
    v_mfma_f32_16x16x32_bf16 v[120:123], v[148:151], v[116:119], 0
    v_cvt_pk_bf16_f32 v205, v190, v191
    v_mfma_f32_16x16x32_bf16 v[132:135], a[60:63], v[52:55], v[132:135]
    s_nop 2
    v_rcp_f32 v124, v124
    s_nop 1
    v_mul_f32 v120, v120, v124
    v_mul_f32 v121, v121, v124
    v_mul_f32 v122, v122, v124
    v_mul_f32 v123, v123, v124
    v_cvt_pk_bf16_f32 v206, v120, v121
    v_cvt_pk_bf16_f32 v207, v122, v123
    s_nop 0
    v_permlane16_swap_b32 v204, v206
    v_permlane16_swap_b32 v205, v207
    buffer_store_dwordx4 v[204:207], v168, s[4:7], s70 offen sc1
    s_nop 1
    s_add_u32 s70, s70, 32768
    v_cvt_pk_bf16_f32 v142, v236, v237
    v_cvt_pk_bf16_f32 v143, v238, v239
    v_cvt_pk_bf16_f32 v156, v128, v129
    v_cvt_pk_bf16_f32 v157, v130, v131
    s_nop 1
    v_mfma_f32_16x16x16_bf16 v[160:163], v[140:141], v[156:157], 0
    v_mfma_f32_16x16x16_bf16 v[164:167], v[142:143], v[156:157], 0
    v_cvt_pk_bf16_f32 v152, v64, v65
    v_cvt_pk_bf16_f32 v153, v66, v67
    s_waitcnt vmcnt(1)
    s_barrier
    s_lshl_b32 s58, s2, 2
    s_add_u32 s58, s58, 0x400
    v_mov_b32 v208, s38
    v_mov_b32 v209, 0
    s_mov_b64 exec, s[50:51]
    buffer_store_dword v208, v209, s[4:7], s58 offen sc1
    s_mov_b64 exec, -1
    v_cvt_pk_bf16_f32 v144, v240, v241
    v_cndmask_b32 v177, v160, v161, s[90:91]
    v_cvt_pk_bf16_f32 v145, v242, v243
    v_cndmask_b32 v179, v162, v163, s[90:91]
    v_cvt_pk_bf16_f32 v158, v132, v133
    v_cndmask_b32 v176, v164, v165, s[90:91]
    v_cvt_pk_bf16_f32 v159, v134, v135
    v_cndmask_b32 v178, v166, v167, s[90:91]
    s_nop 0
    v_mfma_f32_16x16x16_bf16 v[104:107], v[142:143], v[158:159], 0
    v_cndmask_b32 v180, v177, v176, s[92:93]
    v_mfma_f32_16x16x16_bf16 v[108:111], v[144:145], v[158:159], 0
    v_cndmask_b32 v181, v179, v178, s[94:95]
    v_cvt_pk_bf16_f32 v154, v68, v69
    v_max_f32 v182, v180, v181
    v_cvt_pk_bf16_f32 v155, v70, v71
    v_mov_b32 v183, v182
    s_nop 1
    v_permlane32_swap_b32 v183, v182
    v_max_f32 v182, v182, v183
    v_cndmask_b32 v113, v104, v105, s[90:91]
    v_mov_b32 v183, v182
    v_cndmask_b32 v115, v106, v107, s[90:91]
    s_nop 0
    v_permlane16_swap_b32 v183, v182
    v_cndmask_b32 v112, v108, v109, s[90:91]
    v_max_f32 v182, v182, v183
    v_cndmask_b32 v114, v110, v111, s[90:91]
    v_sub_f32 v180, v180, v182
    v_cndmask_b32 v92, v113, v112, s[92:93]
    v_sub_f32 v181, v181, v182
    v_cndmask_b32 v93, v115, v114, s[94:95]
    v_mul_f32 v180, s71, v180
    v_max_f32 v94, v92, v93
    v_mul_f32 v181, s71, v181
    v_mov_b32 v95, v94
    v_exp_f32 v180, v180
    s_nop 0
    v_permlane32_swap_b32 v95, v94
    v_exp_f32 v181, v181
    v_max_f32 v94, v94, v95
    v_cvt_pk_bf16_f32 v180, v180, v180
    v_mov_b32 v95, v94
    v_cvt_pk_bf16_f32 v181, v181, v181
    s_nop 0
    v_permlane16_swap_b32 v95, v94
    v_and_b32 v184, v180, v61
    v_max_f32 v94, v94, v95
    v_and_b32 v185, v181, v59
    v_sub_f32 v92, v92, v94
    v_and_b32 v186, v180, v60
    v_sub_f32 v93, v93, v94
    v_and_b32 v187, v181, v63
    v_mul_f32 v92, s71, v92
    v_mul_f32 v93, s71, v93
    v_mfma_f32_16x16x32_bf16 v[200:203], v[172:175], v[184:187], 0
    v_exp_f32 v92, v92
    v_mfma_f32_16x16x32_bf16 v[188:191], v[150:153], v[184:187], 0
    v_exp_f32 v93, v93
    v_cvt_pk_bf16_f32 v92, v92, v92
    s_nop 3
    v_rcp_f32 v200, v200
    v_cvt_pk_bf16_f32 v93, v93, v93
    v_mul_f32 v188, v188, v200
    v_and_b32 v116, v92, v61
    v_mul_f32 v189, v189, v200
    v_and_b32 v117, v93, v59
    v_mul_f32 v190, v190, v200
    v_and_b32 v118, v92, v60
    v_mul_f32 v191, v191, v200
    v_and_b32 v119, v93, v63
    v_cvt_pk_bf16_f32 v204, v188, v189
    v_cvt_pk_bf16_f32 v205, v190, v191
    v_mfma_f32_16x16x32_bf16 v[124:127], v[172:175], v[116:119], 0
    v_mfma_f32_16x16x32_bf16 v[120:123], v[152:155], v[116:119], 0
    s_nop 6
    v_rcp_f32 v124, v124
    s_nop 0
    v_mul_f32 v120, v120, v124
    v_mul_f32 v121, v121, v124
    v_mul_f32 v122, v122, v124
    v_mul_f32 v123, v123, v124
    v_cvt_pk_bf16_f32 v206, v120, v121
    v_cvt_pk_bf16_f32 v207, v122, v123
    s_nop 0
    v_permlane16_swap_b32 v204, v206
    v_permlane16_swap_b32 v205, v207
    buffer_store_dwordx4 v[204:207], v168, s[4:7], s70 offen sc1
    s_lshl_b32 s58, s52, 12
    s_lshl_b32 s59, s53, 2
    s_add_u32 s58, s58, s59
    s_add_u32 s58, s58, 0x100000
    v_mov_b32 v208, s38
    v_lshlrev_b32 v209, 6, v1
    s_waitcnt vmcnt(0)
    s_barrier
    s_and_b64 exec, s[34:35], s[100:101]
    buffer_store_dword v208, v209, s[4:7], s58 offen
    s_andn2_b64 exec, s[100:101], s[34:35]
    buffer_store_dword v208, v209, s[4:7], s58 offen sc1
    s_mov_b64 exec, -1
    s_add_u32 m0, s17, 0x0
    s_nop 0
    buffer_load_dwordx4 v6, s[40:43], s16 offen lds
    s_add_u32 s16, s16, 32768
    s_add_u32 m0, s17, 0x1000
    s_nop 0
    buffer_load_dwordx4 v6, s[40:43], s16 offen lds
    s_add_u32 s16, s16, 32768
    s_add_u32 m0, s17, 0x2000
    s_nop 0
    buffer_load_dwordx4 v6, s[40:43], s16 offen lds
    s_add_u32 s16, s16, 32768
    s_add_u32 m0, s17, 0x3000
    s_nop 0
    buffer_load_dwordx4 v6, s[40:43], s16 offen lds
    s_add_u32 s16, s16, 32768
    s_add_u32 m0, s17, 0x4000
    s_nop 0
    buffer_load_dwordx4 v6, s[40:43], s16 offen lds
    s_add_u32 s16, s16, 32768
    s_add_u32 m0, s17, 0x5000
    s_nop 0
    buffer_load_dwordx4 v6, s[40:43], s16 offen lds
    s_add_u32 s16, s16, 32768
    s_add_u32 m0, s17, 0x6000
    s_nop 0
    buffer_load_dwordx4 v6, s[40:43], s16 offen lds
    s_add_u32 s16, s16, 32768
    s_add_u32 m0, s17, 0x7000
    s_nop 0
    buffer_load_dwordx4 v6, s[40:43], s16 offen lds
    s_add_u32 s16, s16, 32768
    s_add_u32 m0, s17, 0x8000
    s_nop 0
    buffer_load_dwordx4 v6, s[40:43], s16 offen lds
    s_add_u32 s16, s16, 32768
    s_add_u32 m0, s17, 0x9000
    s_nop 0
    buffer_load_dwordx4 v6, s[40:43], s16 offen lds
    s_add_u32 s16, s16, 32768
    s_add_u32 m0, s17, 0xa000
    s_nop 0
    buffer_load_dwordx4 v6, s[40:43], s16 offen lds
    s_add_u32 s16, s16, 32768
    s_add_u32 m0, s17, 0xb000
    s_nop 0
    buffer_load_dwordx4 v6, s[40:43], s16 offen lds
    s_add_u32 s16, s16, 32768
    s_add_u32 m0, s17, 0xc000
    s_nop 0
    buffer_load_dwordx4 v6, s[40:43], s16 offen lds
    s_add_u32 s16, s16, 32768
    s_add_u32 m0, s17, 0xd000
    s_nop 0
    buffer_load_dwordx4 v6, s[40:43], s16 offen lds
    s_add_u32 s16, s16, 32768
    s_add_u32 m0, s17, 0xe000
    s_nop 0
    buffer_load_dwordx4 v6, s[40:43], s16 offen lds
    s_add_u32 s16, s16, 32768
    s_add_u32 m0, s17, 0xf000
    s_nop 0
    buffer_load_dwordx4 v6, s[40:43], s16 offen lds
    s_add_u32 s16, s16, 32768
    v_lshrrev_b32 v5, 3, v1
    v_lshlrev_b32 v5, 10, v5
    v_and_b32 v6, 7, v1
    v_lshl_add_u32 v5, v6, 4, v5
    s_lshl_b32 s58, s52, 16
    s_lshl_b32 s59, s3, 14
    s_add_u32 s58, s58, s59
    s_lshl_b32 s59, s53, 7
    s_add_u32 s58, s58, s59
    s_lshl_b32 s59, s3, 11
    s_add_u32 m0, s59, 65536
    s_nop 0
    buffer_load_dwordx4 v5, s[8:11], s58 offen lds
    s_add_u32 s58, s58, 8192
    s_add_u32 m0, s59, 66560
    s_nop 0
    buffer_load_dwordx4 v5, s[8:11], s58 offen lds
    s_cmp_eq_u32 s3, 3
    s_cbranch_scc0 L_w3_7
    s_lshl_b32 s69, s52, 12
    s_lshl_b32 s60, s53, 9
    s_add_u32 s69, s69, s60
    s_add_u32 s69, s69, 0x100000
    s_mov_b32 s68, s39
L_poll_10:
    s_min_u32 s60, s68, 7
    s_lshl_b32 s60, s60, 6
    s_add_u32 s58, s69, s60
    s_and_b32 s60, s34, 8
    s_cmp_lt_u32 s68, s60
    s_cbranch_scc0 L_ps_8
    s_load_dwordx8 s[60:67], s[36:37], s58
    s_branch L_pq_9
L_ps_8:
    s_waitcnt lgkmcnt(0)
    s_load_dwordx8 s[60:67], s[36:37], s58 glc
L_pq_9:
    s_waitcnt lgkmcnt(0)
    s_xor_b32 s60, s60, s38
    s_xor_b32 s61, s61, s38
    s_xor_b32 s62, s62, s38
    s_xor_b32 s63, s63, s38
    s_xor_b32 s64, s64, s38
    s_xor_b32 s65, s65, s38
    s_xor_b32 s66, s66, s38
    s_xor_b32 s67, s67, s38
    s_or_b32 s60, s60, s61
    s_or_b32 s62, s62, s63
    s_or_b32 s64, s64, s65
    s_or_b32 s66, s66, s67
    s_or_b32 s60, s60, s62
    s_or_b32 s64, s64, s66
    s_or_b32 s60, s60, s64
    s_add_u32 s68, s68, 1
    s_cmp_eq_u32 s60, 0
    s_cbranch_scc1 L_pdone_11
    s_cmp_lt_u32 s68, 20000
    s_cbranch_scc1 L_poll_10
    s_mov_b32 s39, 20000
L_pdone_11:
    s_waitcnt lgkmcnt(0)
L_w3_7:
    s_waitcnt vmcnt(0)
    s_barrier
    s_lshl_b32 s58, s52, 16
    s_lshl_b32 s59, s3, 14
    s_add_u32 s58, s58, s59
    s_add_u32 s58, s58, 0x600000
    s_add_u32 m0, s59, 0
    s_nop 0
    buffer_load_dwordx4 v4, s[4:7], s58 offen offset:0 sc1 lds
    buffer_load_dwordx4 v4, s[4:7], s58 offen offset:1024 sc1 lds
    buffer_load_dwordx4 v4, s[4:7], s58 offen offset:2048 sc1 lds
    buffer_load_dwordx4 v4, s[4:7], s58 offen offset:3072 sc1 lds
    s_add_u32 s58, s58, 4096
    s_add_u32 m0, s59, 4096
    s_nop 0
    buffer_load_dwordx4 v4, s[4:7], s58 offen offset:0 sc1 lds
    buffer_load_dwordx4 v4, s[4:7], s58 offen offset:1024 sc1 lds
    buffer_load_dwordx4 v4, s[4:7], s58 offen offset:2048 sc1 lds
    buffer_load_dwordx4 v4, s[4:7], s58 offen offset:3072 sc1 lds
    s_add_u32 s58, s58, 4096
    s_add_u32 m0, s59, 8192
    s_nop 0
    buffer_load_dwordx4 v4, s[4:7], s58 offen offset:0 sc1 lds
    buffer_load_dwordx4 v4, s[4:7], s58 offen offset:1024 sc1 lds
    buffer_load_dwordx4 v4, s[4:7], s58 offen offset:2048 sc1 lds
    buffer_load_dwordx4 v4, s[4:7], s58 offen offset:3072 sc1 lds
    s_add_u32 s58, s58, 4096
    s_add_u32 m0, s59, 12288
    s_nop 0
    buffer_load_dwordx4 v4, s[4:7], s58 offen offset:0 sc1 lds
    buffer_load_dwordx4 v4, s[4:7], s58 offen offset:1024 sc1 lds
    buffer_load_dwordx4 v4, s[4:7], s58 offen offset:2048 sc1 lds
    buffer_load_dwordx4 v4, s[4:7], s58 offen offset:3072 sc1 lds
    s_mov_b64 exec, s[100:101]
    s_mov_b32 s58, 0x400
    buffer_load_dwordx4 v[60:63], v4, s[4:7], s58 offen sc1
    s_mov_b64 exec, -1
    v_lshlrev_b32 v5, 5, v3
    s_lshl_b32 s58, s53, 8
    s_lshl_b32 s59, s55, 7
    s_add_u32 s58, s58, s59
    s_add_u32 s58, s58, 0x5000
    buffer_load_dwordx4 v[96:99], v5, s[4:7], s58 offen sc1
    buffer_load_dwordx4 v[100:103], v5, s[4:7], s58 offen offset:16 sc1
    v_lshlrev_b32 v5, 5, v3
    s_lshl_b32 s58, s53, 8
    s_lshl_b32 s59, s55, 7
    s_add_u32 s58, s58, s59
    s_add_u32 s58, s58, 0x6000
    buffer_load_dwordx4 v[104:107], v5, s[4:7], s58 offen sc1
    buffer_load_dwordx4 v[108:111], v5, s[4:7], s58 offen offset:16 sc1
    s_lshl_b32 s58, s3, 10
    s_add_u32 s58, s58, 0x5800
    buffer_load_dwordx4 v[120:123], v4, s[4:7], s58 offen sc1
    v_bfe_u32 v17, v1, 2, 2
    v_lshlrev_b32 v16, 7, v17
    v_lshl_add_u32 v16, v3, 10, v16
    v_and_b32 v17, 2, v17
    v_and_b32 v18, 1, v3
    v_lshl_or_b32 v17, v18, 2, v17
    v_and_b32 v18, 3, v1
    v_xor_b32 v17, v17, v18
    s_lshl_b32 s58, s55, 2
    v_xor_b32 v17, s58, v17
    v_lshl_add_u32 v16, v17, 4, v16
    s_lshl_b32 s58, s54, 15
    s_add_u32 s58, s58, 81920
    v_add_u32 v16, s58, v16
    ds_read_b64_tr_b16 a[192:193], v16 offset:0
    ds_read_b64_tr_b16 a[194:195], v16 offset:512
    ds_read_b64_tr_b16 a[224:225], v16 offset:8
    ds_read_b64_tr_b16 a[226:227], v16 offset:520
    ds_read_b64_tr_b16 a[196:197], v16 offset:4096
    ds_read_b64_tr_b16 a[198:199], v16 offset:4608
    ds_read_b64_tr_b16 a[228:229], v16 offset:4104
    ds_read_b64_tr_b16 a[230:231], v16 offset:4616
    ds_read_b64_tr_b16 a[200:201], v16 offset:8192
    ds_read_b64_tr_b16 a[202:203], v16 offset:8704
    ds_read_b64_tr_b16 a[232:233], v16 offset:8200
    ds_read_b64_tr_b16 a[234:235], v16 offset:8712
    ds_read_b64_tr_b16 a[204:205], v16 offset:12288
    ds_read_b64_tr_b16 a[206:207], v16 offset:12800
    ds_read_b64_tr_b16 a[236:237], v16 offset:12296
    ds_read_b64_tr_b16 a[238:239], v16 offset:12808
    ds_read_b64_tr_b16 a[208:209], v16 offset:16384
    ds_read_b64_tr_b16 a[210:211], v16 offset:16896
    ds_read_b64_tr_b16 a[240:241], v16 offset:16392
    ds_read_b64_tr_b16 a[242:243], v16 offset:16904
    ds_read_b64_tr_b16 a[212:213], v16 offset:20480
    ds_read_b64_tr_b16 a[214:215], v16 offset:20992
    ds_read_b64_tr_b16 a[244:245], v16 offset:20488
    ds_read_b64_tr_b16 a[246:247], v16 offset:21000
    ds_read_b64_tr_b16 a[216:217], v16 offset:24576
    ds_read_b64_tr_b16 a[218:219], v16 offset:25088
    ds_read_b64_tr_b16 a[248:249], v16 offset:24584
    ds_read_b64_tr_b16 a[250:251], v16 offset:25096
    ds_read_b64_tr_b16 a[220:221], v16 offset:28672
    ds_read_b64_tr_b16 a[222:223], v16 offset:29184
    ds_read_b64_tr_b16 a[252:253], v16 offset:28680
    ds_read_b64_tr_b16 a[254:255], v16 offset:29192
    s_cmp_eq_u32 s3, 3
    s_cbranch_scc0 L_w3_12
    s_waitcnt vmcnt(5)
    s_mov_b32 s68, s39
    s_branch L_cc_14
L_cp_13:
    s_sleep 24
    s_mov_b32 s58, 0x400
    buffer_load_dwordx4 v[60:63], v4, s[4:7], s58 offen sc1
    s_waitcnt vmcnt(0)
L_cc_14:
    v_mov_b32 v58, s38
    v_mov_b32 v59, s38
    v_min3_u32 v58, v58, v60, v61
    v_max3_u32 v59, v59, v60, v61
    v_min3_u32 v58, v58, v62, v63
    v_max3_u32 v59, v59, v62, v63
    v_cmp_ne_u32 vcc, v58, v59
    s_add_u32 s68, s68, 1
    s_cbranch_vccz L_pdone_15
    s_cmp_lt_u32 s68, 20000
    s_cbranch_scc1 L_cp_13
    s_mov_b32 s39, 20000
L_pdone_15:
    s_waitcnt lgkmcnt(0)
L_w3_12:
    s_lshl_b32 s58, s54, 13
    s_lshl_b32 s59, s54, 14
    s_add_u32 s58, s58, s59
    v_add_u32 v124, s58, v4
    v_xor_b32 v7, 16384, v124
    s_waitcnt vmcnt(6)
    s_waitcnt lgkmcnt(0)
    s_barrier
    ds_read_b128 v[16:19], v7 offset:0
    ds_read_b128 v[20:23], v7 offset:1024
    ds_read_b128 v[24:27], v7 offset:2048
    ds_read_b128 v[28:31], v7 offset:3072
    s_waitcnt lgkmcnt(3)
    v_mfma_f32_16x16x32_bf16 v[32:35], a[192:195], v[16:19], 0
    s_lshl_b32 s58, s3, 12
    s_add_u32 s58, s58, 81920
    v_add_u32 v125, s58, v4
    v_xor_b32 v126, 8192, v125
    v_lshlrev_b32 v127, 7, v2
    v_lshl_add_u32 v127, v3, 4, v127
    s_lshl_b32 s58, s54, 11
    s_lshl_b32 s59, s55, 6
    s_add_u32 s58, s58, s59
    s_add_u32 s58, s58, 65536
    v_add_u32 v127, s58, v127
    ds_read_b128 v[112:115], v127 offset:0
    ds_read_b128 v[116:119], v127 offset:4096
    s_add_u32 s67, s96, 0x0
    buffer_load_dwordx4 a[0:3], v4, s[4:7], s67 offen offset:0
    v_mfma_f32_16x16x32_bf16 v[36:39], a[224:227], v[16:19], 0
    ds_read_b128 v[16:19], v7 offset:4096
    s_waitcnt lgkmcnt(5)
    v_mfma_f32_16x16x32_bf16 v[32:35], a[196:199], v[20:23], v[32:35]
    v_mfma_f32_16x16x32_bf16 v[36:39], a[228:231], v[20:23], v[36:39]
    v_lshrrev_b32 v6, 1, v3
    v_lshlrev_b32 v6, 2, v6
    v_lshl_add_u32 v6, v2, 7, v6
    s_mov_b32 s76, 0x3f803f80
    s_lshl_b32 s58, s52, 2
    s_add_u32 s58, s58, s54
    s_lshl_b32 s59, s53, 1
    s_add_u32 s59, s59, s55
    s_lshl_b32 s72, s58, 4
    s_add_u32 s72, s72, s59
    s_lshl_b32 s72, s72, 10
    s_add_u32 s72, s72, 0x800000
    s_add_u32 s73, s72, 32768
    s_lshl_b32 s74, s58, 11
    s_lshl_b32 s59, s59, 3
    s_add_u32 s74, s74, s59
    s_add_u32 s74, s74, 0x8000
    s_add_u32 s75, s74, 4096
    s_add_u32 s67, s96, 0x4000
    buffer_load_dwordx4 a[64:67], v4, s[4:7], s67 offen offset:0
    ds_read_b128 v[20:23], v7 offset:5120
    s_waitcnt lgkmcnt(5)
    v_mfma_f32_16x16x32_bf16 v[32:35], a[200:203], v[24:27], v[32:35]
    v_mfma_f32_16x16x32_bf16 v[36:39], a[232:235], v[24:27], v[36:39]
    ds_read_b128 v[24:27], v7 offset:6144
    s_waitcnt lgkmcnt(5)
    v_mfma_f32_16x16x32_bf16 v[32:35], a[204:207], v[28:31], v[32:35]
    s_add_u32 s67, s96, 0x8000
    buffer_load_dwordx4 a[128:131], v4, s[4:7], s67 offen offset:0
    v_mfma_f32_16x16x32_bf16 v[36:39], a[236:239], v[28:31], v[36:39]
    ds_read_b128 v[28:31], v7 offset:7168
    s_waitcnt lgkmcnt(3)
    v_mfma_f32_16x16x32_bf16 v[32:35], a[208:211], v[16:19], v[32:35]
    v_lshlrev_b32 v80, 16, v112
    v_and_b32 v81, 0xffff0000, v112
    v_mfma_f32_16x16x32_bf16 v[36:39], a[240:243], v[16:19], v[36:39]
    v_lshlrev_b32 v82, 16, v113
    v_and_b32 v83, 0xffff0000, v113
    v_lshlrev_b32 v84, 16, v114
    s_add_u32 s67, s96, 0x0
    buffer_load_dwordx4 a[16:19], v4, s[4:7], s67 offen offset:1024
    ds_read_b128 v[16:19], v7 offset:32768
    s_waitcnt lgkmcnt(3)
    v_mfma_f32_16x16x32_bf16 v[32:35], a[212:215], v[20:23], v[32:35]
    v_mfma_f32_16x16x32_bf16 v[36:39], a[244:247], v[20:23], v[36:39]
    v_and_b32 v85, 0xffff0000, v114
    v_lshlrev_b32 v86, 16, v115
    v_and_b32 v87, 0xffff0000, v115
    ds_read_b128 v[20:23], v7 offset:33792
    s_waitcnt lgkmcnt(3)
    v_mfma_f32_16x16x32_bf16 v[32:35], a[216:219], v[24:27], v[32:35]
    v_lshlrev_b32 v88, 16, v116
    v_and_b32 v89, 0xffff0000, v116
    v_lshlrev_b32 v90, 16, v117
    s_add_u32 s67, s96, 0x4000
    buffer_load_dwordx4 a[80:83], v4, s[4:7], s67 offen offset:1024
    v_mfma_f32_16x16x32_bf16 v[36:39], a[248:251], v[24:27], v[36:39]
    ds_read_b128 v[24:27], v7 offset:34816
    s_waitcnt lgkmcnt(3)
    v_mfma_f32_16x16x32_bf16 v[32:35], a[220:223], v[28:31], v[32:35]
    v_and_b32 v91, 0xffff0000, v117
    v_lshlrev_b32 v92, 16, v118
    v_and_b32 v93, 0xffff0000, v118
    v_mfma_f32_16x16x32_bf16 v[36:39], a[252:255], v[28:31], v[36:39]
    v_lshlrev_b32 v94, 16, v119
    v_and_b32 v95, 0xffff0000, v119
    s_add_u32 s67, s96, 0x8000
    buffer_load_dwordx4 a[144:147], v4, s[4:7], s67 offen offset:1024
    ds_read_b128 v[28:31], v7 offset:35840
    s_waitcnt lgkmcnt(3)
    v_mfma_f32_16x16x32_bf16 v[40:43], a[192:195], v[16:19], 0
    v_mfma_f32_16x16x32_bf16 v[44:47], a[224:227], v[16:19], 0
    ds_read_b128 v[16:19], v7 offset:36864
    s_waitcnt lgkmcnt(3)
    v_mfma_f32_16x16x32_bf16 v[40:43], a[196:199], v[20:23], v[40:43]
    s_add_u32 s67, s96, 0x0
    buffer_load_dwordx4 a[32:35], v4, s[4:7], s67 offen offset:2048
    v_mfma_f32_16x16x32_bf16 v[44:47], a[228:231], v[20:23], v[44:47]
    ds_read_b128 v[20:23], v7 offset:37888
    s_waitcnt lgkmcnt(3)
    v_mfma_f32_16x16x32_bf16 v[40:43], a[200:203], v[24:27], v[40:43]
    v_mfma_f32_16x16x32_bf16 v[44:47], a[232:235], v[24:27], v[44:47]
    s_add_u32 s67, s96, 0x4000
    buffer_load_dwordx4 a[96:99], v4, s[4:7], s67 offen offset:2048
    ds_read_b128 v[24:27], v7 offset:38912
    s_waitcnt lgkmcnt(3)
    v_mfma_f32_16x16x32_bf16 v[40:43], a[204:207], v[28:31], v[40:43]
    v_mfma_f32_16x16x32_bf16 v[44:47], a[236:239], v[28:31], v[44:47]
    ds_read_b128 v[28:31], v7 offset:39936
    s_waitcnt lgkmcnt(3)
    v_mfma_f32_16x16x32_bf16 v[40:43], a[208:211], v[16:19], v[40:43]
    s_add_u32 s67, s96, 0x8000
    buffer_load_dwordx4 a[160:163], v4, s[4:7], s67 offen offset:2048
    v_mfma_f32_16x16x32_bf16 v[44:47], a[240:243], v[16:19], v[44:47]
    ds_read_b128 v[16:19], v124 offset:0
    s_waitcnt lgkmcnt(3)
    v_mfma_f32_16x16x32_bf16 v[40:43], a[212:215], v[20:23], v[40:43]
    v_mfma_f32_16x16x32_bf16 v[44:47], a[244:247], v[20:23], v[44:47]
    s_add_u32 s67, s96, 0x0
    buffer_load_dwordx4 a[48:51], v4, s[4:7], s67 offen offset:3072
    ds_read_b128 v[20:23], v124 offset:1024
    s_waitcnt lgkmcnt(3)
    v_mfma_f32_16x16x32_bf16 v[40:43], a[216:219], v[24:27], v[40:43]
    v_mfma_f32_16x16x32_bf16 v[44:47], a[248:251], v[24:27], v[44:47]
    ds_read_b128 v[24:27], v124 offset:2048
    s_waitcnt lgkmcnt(3)
    v_mfma_f32_16x16x32_bf16 v[40:43], a[220:223], v[28:31], v[40:43]
    s_add_u32 s67, s96, 0x4000
    buffer_load_dwordx4 a[112:115], v4, s[4:7], s67 offen offset:3072
    v_mfma_f32_16x16x32_bf16 v[44:47], a[252:255], v[28:31], v[44:47]
    ds_read_b128 v[28:31], v124 offset:3072
    s_waitcnt lgkmcnt(3)
    v_mfma_f32_16x16x32_bf16 v[48:51], a[192:195], v[16:19], 0
    v_mfma_f32_16x16x32_bf16 v[52:55], a[224:227], v[16:19], 0
    s_add_u32 s67, s96, 0x8000
    buffer_load_dwordx4 a[176:179], v4, s[4:7], s67 offen offset:3072
    ds_read_b128 v[16:19], v124 offset:4096
    s_waitcnt lgkmcnt(3)
    v_mfma_f32_16x16x32_bf16 v[48:51], a[196:199], v[20:23], v[48:51]
    ds_write_b128 v125, v[32:35] offset:0
    ds_write_b128 v125, v[36:39] offset:1024
    ds_write_b128 v125, v[40:43] offset:2048
    v_mfma_f32_16x16x32_bf16 v[52:55], a[228:231], v[20:23], v[52:55]
    ds_write_b128 v125, v[44:47] offset:3072
    s_waitcnt vmcnt(12)
    s_mov_b32 s68, s39
    s_branch L_cc_17
    s_nop 3
L_cp_16:
    s_sleep 8
    v_lshlrev_b32 v5, 5, v3
    s_lshl_b32 s58, s53, 8
    s_lshl_b32 s59, s55, 7
    s_add_u32 s58, s58, s59
    s_add_u32 s58, s58, 0x5000
    buffer_load_dwordx4 v[96:99], v5, s[4:7], s58 offen sc1
    buffer_load_dwordx4 v[100:103], v5, s[4:7], s58 offen offset:16 sc1
    v_lshlrev_b32 v5, 5, v3
    s_lshl_b32 s58, s53, 8
    s_lshl_b32 s59, s55, 7
    s_add_u32 s58, s58, s59
    s_add_u32 s58, s58, 0x6000
    buffer_load_dwordx4 v[104:107], v5, s[4:7], s58 offen sc1
    buffer_load_dwordx4 v[108:111], v5, s[4:7], s58 offen offset:16 sc1
    s_lshl_b32 s58, s3, 10
    s_add_u32 s58, s58, 0x5800
    buffer_load_dwordx4 v[120:123], v4, s[4:7], s58 offen sc1
    s_waitcnt vmcnt(0)
L_cc_17:
    v_mov_b32 v64, s38
    v_mov_b32 v65, s38
    v_min3_u32 v64, v64, v97, v99
    v_max3_u32 v65, v65, v97, v99
    v_min3_u32 v64, v64, v101, v103
    v_max3_u32 v65, v65, v101, v103
    v_min3_u32 v64, v64, v105, v107
    v_max3_u32 v65, v65, v105, v107
    v_min3_u32 v64, v64, v109, v111
    v_max3_u32 v65, v65, v109, v111
    v_min3_u32 v64, v64, v121, v123
    v_max3_u32 v65, v65, v121, v123
    v_cmp_ne_u32 vcc, v64, v65
    s_add_u32 s68, s68, 1
    s_cbranch_vccz L_pdone_18
    s_cmp_lt_u32 s68, 20000
    s_cbranch_scc1 L_cp_16
    s_mov_b32 s39, 20000
L_pdone_18:
    s_lshl_b32 s58, s3, 9
    s_add_u32 s58, s58, 155648
    v_lshl_add_u32 v5, v1, 3, s58
    v_mov_b32 v121, v122
    ds_write_b64 v5, v[120:121]
    ds_read_b128 v[20:23], v124 offset:5120
    s_waitcnt lgkmcnt(8)
    v_mfma_f32_16x16x32_bf16 v[48:51], a[200:203], v[24:27], v[48:51]
    s_add_u32 s67, s96, 0x1000
    buffer_load_dwordx4 a[4:7], v4, s[4:7], s67 offen offset:0
    v_mfma_f32_16x16x32_bf16 v[52:55], a[232:235], v[24:27], v[52:55]
    ds_read_b128 v[24:27], v124 offset:6144
    s_waitcnt lgkmcnt(8)
    v_mfma_f32_16x16x32_bf16 v[48:51], a[204:207], v[28:31], v[48:51]
    v_mfma_f32_16x16x32_bf16 v[52:55], a[236:239], v[28:31], v[52:55]
    s_add_u32 s67, s96, 0x5000
    buffer_load_dwordx4 a[68:71], v4, s[4:7], s67 offen offset:0
    ds_read_b128 v[28:31], v124 offset:7168
    s_waitcnt lgkmcnt(8)
    v_mfma_f32_16x16x32_bf16 v[48:51], a[208:211], v[16:19], v[48:51]
    v_mfma_f32_16x16x32_bf16 v[52:55], a[240:243], v[16:19], v[52:55]
    ds_read_b128 v[16:19], v124 offset:32768
    s_waitcnt lgkmcnt(3)
    v_mfma_f32_16x16x32_bf16 v[48:51], a[212:215], v[20:23], v[48:51]
    v_and_b32 v97, 0xffff0000, v96
    v_lshlrev_b32 v96, 16, v96
    v_and_b32 v99, 0xffff0000, v98
    s_add_u32 s67, s96, 0x9000
    buffer_load_dwordx4 a[132:135], v4, s[4:7], s67 offen offset:0
    v_mfma_f32_16x16x32_bf16 v[52:55], a[244:247], v[20:23], v[52:55]
    ds_read_b128 v[20:23], v124 offset:33792
    s_waitcnt lgkmcnt(3)
    v_mfma_f32_16x16x32_bf16 v[48:51], a[216:219], v[24:27], v[48:51]
    v_lshlrev_b32 v98, 16, v98
    v_and_b32 v101, 0xffff0000, v100
    v_lshlrev_b32 v100, 16, v100
    v_mfma_f32_16x16x32_bf16 v[52:55], a[248:251], v[24:27], v[52:55]
    v_and_b32 v103, 0xffff0000, v102
    v_lshlrev_b32 v102, 16, v102
    v_and_b32 v105, 0xffff0000, v104
    s_add_u32 s67, s96, 0x1000
    buffer_load_dwordx4 a[20:23], v4, s[4:7], s67 offen offset:1024
    ds_read_b128 v[24:27], v124 offset:34816
    s_waitcnt lgkmcnt(3)
    v_mfma_f32_16x16x32_bf16 v[48:51], a[220:223], v[28:31], v[48:51]
    v_mfma_f32_16x16x32_bf16 v[52:55], a[252:255], v[28:31], v[52:55]
    v_lshlrev_b32 v104, 16, v104
    v_and_b32 v107, 0xffff0000, v106
    v_lshlrev_b32 v106, 16, v106
    ds_read_b128 v[28:31], v124 offset:35840
    s_waitcnt lgkmcnt(3)
    v_mfma_f32_16x16x32_bf16 v[56:59], a[192:195], v[16:19], 0
    v_and_b32 v109, 0xffff0000, v108
    v_lshlrev_b32 v108, 16, v108
    v_and_b32 v111, 0xffff0000, v110
    s_add_u32 s67, s96, 0x5000
    buffer_load_dwordx4 a[84:87], v4, s[4:7], s67 offen offset:1024
    v_mfma_f32_16x16x32_bf16 v[60:63], a[224:227], v[16:19], 0
    ds_read_b128 v[16:19], v124 offset:36864
    s_waitcnt lgkmcnt(3)
    v_mfma_f32_16x16x32_bf16 v[56:59], a[196:199], v[20:23], v[56:59]
    v_lshlrev_b32 v110, 16, v110
    v_mfma_f32_16x16x32_bf16 v[60:63], a[228:231], v[20:23], v[60:63]
    s_add_u32 s67, s96, 0x9000
    buffer_load_dwordx4 a[148:151], v4, s[4:7], s67 offen offset:1024
    ds_read_b128 v[20:23], v124 offset:37888
    s_waitcnt lgkmcnt(3)
    v_mfma_f32_16x16x32_bf16 v[56:59], a[200:203], v[24:27], v[56:59]
    v_mfma_f32_16x16x32_bf16 v[60:63], a[232:235], v[24:27], v[60:63]
    ds_read_b128 v[24:27], v124 offset:38912
    s_waitcnt lgkmcnt(3)
    v_mfma_f32_16x16x32_bf16 v[56:59], a[204:207], v[28:31], v[56:59]
    s_add_u32 s67, s96, 0x1000
    buffer_load_dwordx4 a[36:39], v4, s[4:7], s67 offen offset:2048
    v_mfma_f32_16x16x32_bf16 v[60:63], a[236:239], v[28:31], v[60:63]
    ds_read_b128 v[28:31], v124 offset:39936
    s_waitcnt lgkmcnt(3)
    v_mfma_f32_16x16x32_bf16 v[56:59], a[208:211], v[16:19], v[56:59]
    v_mfma_f32_16x16x32_bf16 v[60:63], a[240:243], v[16:19], v[60:63]
    s_add_u32 s67, s96, 0x5000
    buffer_load_dwordx4 a[100:103], v4, s[4:7], s67 offen offset:2048
    s_waitcnt lgkmcnt(2)
    v_mfma_f32_16x16x32_bf16 v[56:59], a[212:215], v[20:23], v[56:59]
    v_mfma_f32_16x16x32_bf16 v[60:63], a[244:247], v[20:23], v[60:63]
    s_waitcnt lgkmcnt(1)
    v_mfma_f32_16x16x32_bf16 v[56:59], a[216:219], v[24:27], v[56:59]
    v_mfma_f32_16x16x32_bf16 v[60:63], a[248:251], v[24:27], v[60:63]
    s_waitcnt lgkmcnt(0)
    v_mfma_f32_16x16x32_bf16 v[56:59], a[220:223], v[28:31], v[56:59]
    v_mfma_f32_16x16x32_bf16 v[60:63], a[252:255], v[28:31], v[60:63]
    s_barrier
    ds_read_b128 v[64:67], v126 offset:0
    ds_read_b128 v[68:71], v126 offset:1024
    ds_read_b128 v[72:75], v126 offset:2048
    ds_read_b128 v[76:79], v126 offset:3072
    s_waitcnt lgkmcnt(3)
    v_pk_add_f32 v[48:49], v[48:49], v[64:65]
    v_pk_add_f32 v[50:51], v[50:51], v[66:67]
    s_waitcnt lgkmcnt(2)
    v_pk_add_f32 v[52:53], v[52:53], v[68:69]
    v_pk_add_f32 v[54:55], v[54:55], v[70:71]
    v_pk_fma_f32 v[80:81], v[96:97], v[48:49], v[80:81]
    v_pk_fma_f32 v[82:83], v[98:99], v[50:51], v[82:83]
    v_pk_fma_f32 v[84:85], v[100:101], v[52:53], v[84:85]
    v_pk_fma_f32 v[86:87], v[102:103], v[54:55], v[86:87]
    v_pk_mul_f32 v[48:49], v[80:81], v[104:105]
    v_pk_mul_f32 v[50:51], v[82:83], v[106:107]
    v_pk_mul_f32 v[52:53], v[84:85], v[108:109]
    v_pk_mul_f32 v[54:55], v[86:87], v[110:111]
    v_cvt_pk_bf16_f32 v32, v48, v49
    v_cvt_pk_bf16_f32 v33, v50, v51
    v_cvt_pk_bf16_f32 v34, v52, v53
    v_cvt_pk_bf16_f32 v35, v54, v55
    v_cvt_pk_bf16_f32 v8, v80, v81
    v_cvt_pk_bf16_f32 v9, v82, v83
    v_cvt_pk_bf16_f32 v10, v84, v85
    v_cvt_pk_bf16_f32 v11, v86, v87
    s_waitcnt lgkmcnt(1)
    v_pk_add_f32 v[56:57], v[56:57], v[72:73]
    v_pk_add_f32 v[58:59], v[58:59], v[74:75]
    s_waitcnt lgkmcnt(0)
    v_pk_add_f32 v[60:61], v[60:61], v[76:77]
    v_pk_add_f32 v[62:63], v[62:63], v[78:79]
    v_pk_fma_f32 v[88:89], v[96:97], v[56:57], v[88:89]
    v_pk_fma_f32 v[90:91], v[98:99], v[58:59], v[90:91]
    v_pk_fma_f32 v[92:93], v[100:101], v[60:61], v[92:93]
    v_pk_fma_f32 v[94:95], v[102:103], v[62:63], v[94:95]
    v_pk_mul_f32 v[56:57], v[88:89], v[104:105]
    v_pk_mul_f32 v[58:59], v[90:91], v[106:107]
    v_pk_mul_f32 v[60:61], v[92:93], v[108:109]
    v_pk_mul_f32 v[62:63], v[94:95], v[110:111]
    v_cvt_pk_bf16_f32 v36, v56, v57
    v_cvt_pk_bf16_f32 v37, v58, v59
    v_cvt_pk_bf16_f32 v38, v60, v61
    v_cvt_pk_bf16_f32 v39, v62, v63
    v_cvt_pk_bf16_f32 v12, v88, v89
    v_cvt_pk_bf16_f32 v13, v90, v91
    v_cvt_pk_bf16_f32 v14, v92, v93
    v_cvt_pk_bf16_f32 v15, v94, v95
    s_mov_b64 exec, s[34:35]
    buffer_store_dwordx4 v[32:35], v4, s[4:7], s72 offen
    buffer_store_dwordx4 v[36:39], v4, s[4:7], s73 offen
    s_not_b64 exec, s[34:35]
    buffer_store_dwordx4 v[32:35], v4, s[4:7], s72 offen sc1
    buffer_store_dwordx4 v[36:39], v4, s[4:7], s73 offen sc1
    s_mov_b64 exec, -1
    v_dot2_f32_bf16 v40, v8, s76, 0
    v_dot2_f32_bf16 v42, v12, s76, 0
    v_dot2_f32_bf16 v41, v8, v8, 0
    v_dot2_f32_bf16 v43, v12, v12, 0
    v_dot2_f32_bf16 v40, v9, s76, v40
    v_dot2_f32_bf16 v42, v13, s76, v42
    v_dot2_f32_bf16 v41, v9, v9, v41
    v_dot2_f32_bf16 v43, v13, v13, v43
    v_dot2_f32_bf16 v40, v10, s76, v40
    v_dot2_f32_bf16 v42, v14, s76, v42
    v_dot2_f32_bf16 v41, v10, v10, v41
    v_dot2_f32_bf16 v43, v14, v14, v43
    v_dot2_f32_bf16 v40, v11, s76, v40
    v_dot2_f32_bf16 v42, v15, s76, v42
    v_dot2_f32_bf16 v41, v11, v11, v41
    v_dot2_f32_bf16 v43, v15, v15, v43
    s_nop 1
    v_permlane32_swap_b32 v40, v41
    v_permlane32_swap_b32 v42, v43
    v_add_f32 v40, v40, v41
    v_add_f32 v42, v42, v43
    v_mov_b32 v41, v40
    v_mov_b32 v43, v42
    s_nop 0
    v_permlane16_swap_b32 v41, v40
    v_permlane16_swap_b32 v43, v42
    v_add_f32 v40, v40, v41
    v_add_f32 v42, v42, v43
    s_mov_b64 exec, s[34:35]
    buffer_store_dword v40, v6, s[4:7], s74 offen
    buffer_store_dword v42, v6, s[4:7], s75 offen
    s_not_b64 exec, s[34:35]
    buffer_store_dword v40, v6, s[4:7], s74 offen sc1
    buffer_store_dword v42, v6, s[4:7], s75 offen sc1
    s_mov_b64 exec, -1
    s_lshl_b32 s58, s52, 12
    s_lshl_b32 s59, s53, 2
    s_add_u32 s58, s58, s59
    s_add_u32 s58, s58, 0x120000
    v_mov_b32 v16, s38
    v_lshlrev_b32 v17, 6, v1
    s_waitcnt vmcnt(0)
    s_barrier
    s_and_b64 exec, s[34:35], s[100:101]
    buffer_store_dword v16, v17, s[4:7], s58 offen
    s_andn2_b64 exec, s[100:101], s[34:35]
    buffer_store_dword v16, v17, s[4:7], s58 offen sc1
    s_mov_b64 exec, -1
    s_add_u32 s67, s96, 0x9000
    buffer_load_dwordx4 a[164:167], v4, s[4:7], s67 offen offset:2048
    s_add_u32 s67, s96, 0x1000
    buffer_load_dwordx4 a[52:55], v4, s[4:7], s67 offen offset:3072
    s_add_u32 s67, s96, 0x5000
    buffer_load_dwordx4 a[116:119], v4, s[4:7], s67 offen offset:3072
    s_add_u32 s67, s96, 0x9000
    buffer_load_dwordx4 a[180:183], v4, s[4:7], s67 offen offset:3072
    s_add_u32 s67, s96, 0x2000
    buffer_load_dwordx4 a[8:11], v4, s[4:7], s67 offen offset:0
    s_add_u32 s67, s96, 0x6000
    buffer_load_dwordx4 a[72:75], v4, s[4:7], s67 offen offset:0
    s_add_u32 s67, s96, 0xa000
    buffer_load_dwordx4 a[136:139], v4, s[4:7], s67 offen offset:0
    s_add_u32 s67, s96, 0x2000
    buffer_load_dwordx4 a[24:27], v4, s[4:7], s67 offen offset:1024
    s_add_u32 s67, s96, 0x6000
    buffer_load_dwordx4 a[88:91], v4, s[4:7], s67 offen offset:1024
    s_add_u32 s67, s96, 0xa000
    buffer_load_dwordx4 a[152:155], v4, s[4:7], s67 offen offset:1024
    s_add_u32 s67, s96, 0x2000
    buffer_load_dwordx4 a[40:43], v4, s[4:7], s67 offen offset:2048
    s_add_u32 s67, s96, 0x6000
    buffer_load_dwordx4 a[104:107], v4, s[4:7], s67 offen offset:2048
    s_add_u32 s67, s96, 0xa000
    buffer_load_dwordx4 a[168:171], v4, s[4:7], s67 offen offset:2048
    s_add_u32 s67, s96, 0x2000
    buffer_load_dwordx4 a[56:59], v4, s[4:7], s67 offen offset:3072
    s_lshl_b32 s70, s53, 2
    s_lshl_b32 s59, s55, 1
    s_add_u32 s70, s70, s59
    s_mul_i32 s70, s70, 0xac00
    s_mul_i32 s59, s54, 22528
    s_add_u32 s70, s70, s59
    s_add_u32 s70, s70, 0x480000
    v_mov_b32 v59, 0xbfb8aa3b
    v_and_b32 v56, 1, v3
    v_mul_u32_u24 v56, 0xac00, v56
    v_lshrrev_b32 v5, 1, v3
    v_lshl_add_u32 v5, v5, 4, v2
    v_lshl_add_u32 v56, v5, 4, v56
    s_mul_i32 s71, s52, 0x2b000
    s_lshl_b32 s58, s97, 9
    s_add_u32 s71, s71, s58
    s_add_u32 s71, s71, 0xa00000
    s_mov_b32 s72, 0xbfb8aa3b
    v_and_b32 v57, 1, v2
    v_xor_b32 v57, 1, v57
    v_lshlrev_b32 v57, 10, v57
    v_lshl_add_u32 v57, v3, 4, v57
    v_add_u32 v57, 155648, v57
    v_lshlrev_b32 v58, 7, v2
    v_lshl_add_u32 v58, v3, 5, v58
    v_add_u32 v58, 65536, v58
    s_cmp_eq_u32 s3, 3
    s_cbranch_scc0 L_w3_19
    s_lshl_b32 s69, s52, 12
    s_lshl_b32 s60, s53, 9
    s_add_u32 s69, s69, s60
    s_add_u32 s69, s69, 0x120000
    s_mov_b32 s68, s39
L_poll_22:
    s_min_u32 s60, s68, 7
    s_lshl_b32 s60, s60, 6
    s_add_u32 s58, s69, s60
    s_and_b32 s60, s34, 8
    s_cmp_lt_u32 s68, s60
    s_cbranch_scc0 L_ps_20
    s_load_dwordx8 s[60:67], s[36:37], s58
    s_branch L_pq_21
L_ps_20:
    s_waitcnt lgkmcnt(0)
    s_load_dwordx8 s[60:67], s[36:37], s58 glc
L_pq_21:
    s_waitcnt lgkmcnt(0)
    s_xor_b32 s60, s60, s38
    s_xor_b32 s61, s61, s38
    s_xor_b32 s62, s62, s38
    s_xor_b32 s63, s63, s38
    s_xor_b32 s64, s64, s38
    s_xor_b32 s65, s65, s38
    s_xor_b32 s66, s66, s38
    s_xor_b32 s67, s67, s38
    s_or_b32 s60, s60, s61
    s_or_b32 s62, s62, s63
    s_or_b32 s64, s64, s65
    s_or_b32 s66, s66, s67
    s_or_b32 s60, s60, s62
    s_or_b32 s64, s64, s66
    s_or_b32 s60, s60, s64
    s_add_u32 s68, s68, 1
    s_cmp_eq_u32 s60, 0
    s_cbranch_scc1 L_pdone_23
    s_cmp_lt_u32 s68, 20000
    s_cbranch_scc1 L_poll_22
    s_mov_b32 s39, 20000
L_pdone_23:
    s_waitcnt lgkmcnt(0)
L_w3_19:
    s_barrier
    s_lshl_b32 s58, s52, 16
    s_lshl_b32 s59, s3, 14
    s_add_u32 s58, s58, s59
    s_add_u32 s58, s58, 0x800000
    s_add_u32 m0, s59, 0
    s_nop 0
    buffer_load_dwordx4 v4, s[4:7], s58 offen offset:0 sc1 lds
    buffer_load_dwordx4 v4, s[4:7], s58 offen offset:1024 sc1 lds
    buffer_load_dwordx4 v4, s[4:7], s58 offen offset:2048 sc1 lds
    buffer_load_dwordx4 v4, s[4:7], s58 offen offset:3072 sc1 lds
    s_add_u32 s58, s58, 4096
    s_add_u32 m0, s59, 4096
    s_nop 0
    buffer_load_dwordx4 v4, s[4:7], s58 offen offset:0 sc1 lds
    buffer_load_dwordx4 v4, s[4:7], s58 offen offset:1024 sc1 lds
    buffer_load_dwordx4 v4, s[4:7], s58 offen offset:2048 sc1 lds
    buffer_load_dwordx4 v4, s[4:7], s58 offen offset:3072 sc1 lds
    s_add_u32 s58, s58, 4096
    s_add_u32 m0, s59, 8192
    s_nop 0
    buffer_load_dwordx4 v4, s[4:7], s58 offen offset:0 sc1 lds
    buffer_load_dwordx4 v4, s[4:7], s58 offen offset:1024 sc1 lds
    buffer_load_dwordx4 v4, s[4:7], s58 offen offset:2048 sc1 lds
    buffer_load_dwordx4 v4, s[4:7], s58 offen offset:3072 sc1 lds
    s_add_u32 s58, s58, 4096
    s_add_u32 m0, s59, 12288
    s_nop 0
    buffer_load_dwordx4 v4, s[4:7], s58 offen offset:0 sc1 lds
    buffer_load_dwordx4 v4, s[4:7], s58 offen offset:1024 sc1 lds
    buffer_load_dwordx4 v4, s[4:7], s58 offen offset:2048 sc1 lds
    buffer_load_dwordx4 v4, s[4:7], s58 offen offset:3072 sc1 lds
    s_lshl_b32 s58, s52, 13
    s_lshl_b32 s59, s3, 11
    s_add_u32 s58, s58, s59
    s_add_u32 s58, s58, 0x8000
    s_add_u32 m0, s59, 65536
    s_nop 0
    buffer_load_dwordx4 v4, s[4:7], s58 offen offset:0 sc1 lds
    buffer_load_dwordx4 v4, s[4:7], s58 offen offset:1024 sc1 lds
    s_add_u32 s67, s96, 0x6000
    buffer_load_dwordx4 a[120:123], v4, s[4:7], s67 offen offset:3072
    s_add_u32 s67, s96, 0xa000
    buffer_load_dwordx4 a[184:187], v4, s[4:7], s67 offen offset:3072
    s_add_u32 s67, s96, 0x3000
    buffer_load_dwordx4 a[12:15], v4, s[4:7], s67 offen offset:0
    s_add_u32 s67, s96, 0x7000
    buffer_load_dwordx4 a[76:79], v4, s[4:7], s67 offen offset:0
    s_add_u32 s67, s96, 0xb000
    buffer_load_dwordx4 a[140:143], v4, s[4:7], s67 offen offset:0
    s_add_u32 s67, s96, 0x3000
    buffer_load_dwordx4 a[28:31], v4, s[4:7], s67 offen offset:1024
    s_add_u32 s67, s96, 0x7000
    buffer_load_dwordx4 a[92:95], v4, s[4:7], s67 offen offset:1024
    s_add_u32 s67, s96, 0xb000
    buffer_load_dwordx4 a[156:159], v4, s[4:7], s67 offen offset:1024
    s_waitcnt vmcnt(8)
    s_barrier
    s_add_u32 s67, s96, 0x3000
    buffer_load_dwordx4 a[44:47], v4, s[4:7], s67 offen offset:2048
    ds_read_b128 v[16:19], v4 offset:0
    ds_read_b128 v[20:23], v4 offset:1024
    ds_read_b128 v[24:27], v4 offset:2048
    ds_read_b128 v[28:31], v4 offset:3072
    s_waitcnt lgkmcnt(3)
    v_mfma_f32_16x16x32_bf16 v[32:35], a[0:3], v[16:19], 0
    s_add_u32 s67, s96, 0x7000
    buffer_load_dwordx4 a[108:111], v4, s[4:7], s67 offen offset:2048
    v_mfma_f32_16x16x32_bf16 v[36:39], a[64:67], v[16:19], 0
    s_add_u32 s67, s96, 0xb000
    buffer_load_dwordx4 a[172:175], v4, s[4:7], s67 offen offset:2048
    v_mfma_f32_16x16x32_bf16 v[40:43], a[128:131], v[16:19], 0
    s_add_u32 s67, s96, 0x3000
    buffer_load_dwordx4 a[60:63], v4, s[4:7], s67 offen offset:3072
    ds_read_b128 v[16:19], v4 offset:4096
    s_waitcnt lgkmcnt(3)
    v_mfma_f32_16x16x32_bf16 v[32:35], a[16:19], v[20:23], v[32:35]
    s_add_u32 s67, s96, 0x7000
    buffer_load_dwordx4 a[124:127], v4, s[4:7], s67 offen offset:3072
    v_mfma_f32_16x16x32_bf16 v[36:39], a[80:83], v[20:23], v[36:39]
    s_add_u32 s67, s96, 0xb000
    buffer_load_dwordx4 a[188:191], v4, s[4:7], s67 offen offset:3072
    v_mfma_f32_16x16x32_bf16 v[40:43], a[144:147], v[20:23], v[40:43]
    ds_read_b128 v[20:23], v4 offset:5120
    s_waitcnt lgkmcnt(3)
    v_mfma_f32_16x16x32_bf16 v[32:35], a[32:35], v[24:27], v[32:35]
    v_mfma_f32_16x16x32_bf16 v[36:39], a[96:99], v[24:27], v[36:39]
    v_mfma_f32_16x16x32_bf16 v[40:43], a[160:163], v[24:27], v[40:43]
    ds_read_b128 v[96:99], v58 offset:0
    ds_read_b128 v[104:107], v58 offset:2048
    ds_read_b128 v[112:115], v58 offset:4096
    ds_read_b128 v[24:27], v4 offset:6144
    s_waitcnt lgkmcnt(6)
    v_mfma_f32_16x16x32_bf16 v[32:35], a[48:51], v[28:31], v[32:35]
    ds_read_b128 v[120:123], v58 offset:6144
    ds_read_b128 v[100:103], v58 offset:16
    ds_read_b128 v[108:111], v58 offset:2064
    ds_read_b128 v[116:119], v58 offset:4112
    ds_read_b128 v[124:127], v58 offset:6160
    v_mfma_f32_16x16x32_bf16 v[36:39], a[112:115], v[28:31], v[36:39]
    s_add_u32 s67, s70, 0x0
    buffer_load_dwordx4 v[128:131], v4, s[4:7], s67 offen offset:0
    v_mfma_f32_16x16x32_bf16 v[40:43], a[176:179], v[28:31], v[40:43]
    ds_read_b128 v[28:31], v4 offset:7168
    s_waitcnt lgkmcnt(11)
    v_mfma_f32_16x16x32_bf16 v[32:35], a[4:7], v[16:19], v[32:35]
    s_waitcnt lgkmcnt(9)
    v_add_f32 v96, v96, v98
    v_mfma_f32_16x16x32_bf16 v[36:39], a[68:71], v[16:19], v[36:39]
    s_waitcnt lgkmcnt(8)
    v_add_f32 v104, v104, v106
    s_waitcnt lgkmcnt(7)
    v_add_f32 v112, v112, v114
    v_mfma_f32_16x16x32_bf16 v[40:43], a[132:135], v[16:19], v[40:43]
    s_waitcnt lgkmcnt(5)
    v_add_f32 v120, v120, v122
    s_add_u32 s67, s70, 0xa000
    buffer_load_dwordx4 v[216:219], v4, s[4:7], s67 offen offset:3072
    v_add_f32 v97, v97, v99
    ds_read_b128 v[16:19], v4 offset:8192
    v_mfma_f32_16x16x32_bf16 v[32:35], a[20:23], v[20:23], v[32:35]
    v_add_f32 v105, v105, v107
    v_add_f32 v113, v113, v115
    v_mfma_f32_16x16x32_bf16 v[36:39], a[84:87], v[20:23], v[36:39]
    v_add_f32 v121, v121, v123
    s_waitcnt lgkmcnt(5)
    v_add_f32 v96, v96, v100
    v_mfma_f32_16x16x32_bf16 v[40:43], a[148:151], v[20:23], v[40:43]
    s_waitcnt lgkmcnt(4)
    v_add_f32 v104, v104, v108
    s_waitcnt lgkmcnt(3)
    v_add_f32 v112, v112, v116
    ds_read_b128 v[20:23], v4 offset:9216
    v_mfma_f32_16x16x32_bf16 v[32:35], a[36:39], v[24:27], v[32:35]
    s_waitcnt lgkmcnt(3)
    v_add_f32 v120, v120, v124
    s_add_u32 s67, s70, 0x0
    buffer_load_dwordx4 v[132:135], v4, s[4:7], s67 offen offset:1024
    v_mfma_f32_16x16x32_bf16 v[36:39], a[100:103], v[24:27], v[36:39]
    v_add_f32 v97, v97, v101
    v_add_f32 v105, v105, v109
    v_add_f32 v113, v113, v117
    v_mfma_f32_16x16x32_bf16 v[40:43], a[164:167], v[24:27], v[40:43]
    v_add_f32 v121, v121, v125
    v_add_f32 v96, v96, v102
    ds_read_b128 v[24:27], v4 offset:10240
    s_waitcnt lgkmcnt(3)
    v_mfma_f32_16x16x32_bf16 v[32:35], a[52:55], v[28:31], v[32:35]
    v_add_f32 v104, v104, v110
    v_add_f32 v112, v112, v118
    v_mfma_f32_16x16x32_bf16 v[36:39], a[116:119], v[28:31], v[36:39]
    v_add_f32 v120, v120, v126
    s_add_u32 s67, s70, 0xb000
    buffer_load_dwordx4 v[220:223], v4, s[4:7], s67 offen offset:0
    v_mfma_f32_16x16x32_bf16 v[40:43], a[180:183], v[28:31], v[40:43]
    v_add_f32 v97, v97, v103
    v_add_f32 v105, v105, v111
    ds_read_b128 v[28:31], v4 offset:11264
    s_waitcnt lgkmcnt(3)
    v_mfma_f32_16x16x32_bf16 v[32:35], a[8:11], v[16:19], v[32:35]
    v_add_f32 v113, v113, v119
    v_add_f32 v121, v121, v127
    v_permlane32_swap_b32 v96, v97
    v_mfma_f32_16x16x32_bf16 v[36:39], a[72:75], v[16:19], v[36:39]
    v_permlane32_swap_b32 v104, v105
    v_mfma_f32_16x16x32_bf16 v[40:43], a[136:139], v[16:19], v[40:43]
    v_permlane32_swap_b32 v112, v113
    ds_read_b128 v[16:19], v4 offset:12288
    s_waitcnt lgkmcnt(3)
    v_mfma_f32_16x16x32_bf16 v[32:35], a[24:27], v[20:23], v[32:35]
    v_permlane32_swap_b32 v120, v121
    v_mfma_f32_16x16x32_bf16 v[36:39], a[88:91], v[20:23], v[36:39]
    s_add_u32 s67, s70, 0x0
    buffer_load_dwordx4 v[136:139], v4, s[4:7], s67 offen offset:2048
    v_mfma_f32_16x16x32_bf16 v[40:43], a[152:155], v[20:23], v[40:43]
    v_add_f32 v96, v96, v97
    v_add_f32 v104, v104, v105
    v_add_f32 v112, v112, v113
    ds_read_b128 v[20:23], v4 offset:13312
    s_waitcnt lgkmcnt(3)
    v_mfma_f32_16x16x32_bf16 v[32:35], a[40:43], v[24:27], v[32:35]
    v_add_f32 v120, v120, v121
    v_mov_b32 v97, v96
    v_mfma_f32_16x16x32_bf16 v[36:39], a[104:107], v[24:27], v[36:39]
    v_mov_b32 v105, v104
    v_mov_b32 v113, v112
    v_mfma_f32_16x16x32_bf16 v[40:43], a[168:171], v[24:27], v[40:43]
    v_mov_b32 v121, v120
    s_add_u32 s67, s70, 0xb000
    buffer_load_dwordx4 v[224:227], v4, s[4:7], s67 offen offset:1024
    ds_read_b128 v[24:27], v4 offset:14336
    s_waitcnt lgkmcnt(3)
    v_mfma_f32_16x16x32_bf16 v[32:35], a[56:59], v[28:31], v[32:35]
    v_permlane16_swap_b32 v97, v96
    s_waitcnt vmcnt(19)
    v_mfma_f32_16x16x32_bf16 v[36:39], a[120:123], v[28:31], v[36:39]
    v_permlane16_swap_b32 v105, v104
    v_permlane16_swap_b32 v113, v112
    s_waitcnt vmcnt(18)
    v_mfma_f32_16x16x32_bf16 v[40:43], a[184:187], v[28:31], v[40:43]
    v_permlane16_swap_b32 v121, v120
    ds_read_b128 v[28:31], v4 offset:15360
    s_waitcnt vmcnt(17) lgkmcnt(3)
    v_mfma_f32_16x16x32_bf16 v[32:35], a[12:15], v[16:19], v[32:35]
    v_add_f32 v96, v96, v97
    s_waitcnt vmcnt(16)
    v_mfma_f32_16x16x32_bf16 v[36:39], a[76:79], v[16:19], v[36:39]
    v_add_f32 v104, v104, v105
    v_add_f32 v112, v112, v113
    s_waitcnt vmcnt(15)
    v_mfma_f32_16x16x32_bf16 v[40:43], a[140:143], v[16:19], v[40:43]
    v_add_f32 v120, v120, v121
    s_add_u32 s67, s70, 0x0
    buffer_load_dwordx4 v[140:143], v4, s[4:7], s67 offen offset:3072
    ds_read_b128 v[16:19], v57 offset:0
    s_waitcnt vmcnt(15) lgkmcnt(3)
    v_mfma_f32_16x16x32_bf16 v[32:35], a[28:31], v[20:23], v[32:35]
    v_mov_b32 v97, v96
    v_mov_b32 v105, v104
    v_mov_b32 v113, v112
    s_waitcnt vmcnt(14)
    v_mfma_f32_16x16x32_bf16 v[36:39], a[92:95], v[20:23], v[36:39]
    v_mov_b32 v121, v120
    v_permlane32_swap_b32 v96, v97
    s_waitcnt vmcnt(13)
    v_mfma_f32_16x16x32_bf16 v[40:43], a[156:159], v[20:23], v[40:43]
    v_permlane32_swap_b32 v104, v105
    ds_read_b128 v[20:23], v57 offset:64
    s_waitcnt vmcnt(12) lgkmcnt(3)
    v_mfma_f32_16x16x32_bf16 v[32:35], a[44:47], v[24:27], v[32:35]
    v_permlane32_swap_b32 v112, v113
    s_waitcnt vmcnt(11)
    v_mfma_f32_16x16x32_bf16 v[36:39], a[108:111], v[24:27], v[36:39]
    v_permlane32_swap_b32 v120, v121
    s_waitcnt vmcnt(10)
    v_mfma_f32_16x16x32_bf16 v[40:43], a[172:175], v[24:27], v[40:43]
    s_add_u32 s67, s70, 0xb000
    buffer_load_dwordx4 v[228:231], v4, s[4:7], s67 offen offset:2048
    v_mul_f32 v96, 0x3b000000, v96
    ds_read_b128 v[24:27], v57 offset:128
    s_waitcnt vmcnt(10) lgkmcnt(3)
    v_mfma_f32_16x16x32_bf16 v[32:35], a[60:63], v[28:31], v[32:35]
    v_mul_f32 v104, 0x3b000000, v104
    v_mul_f32 v112, 0x3b000000, v112
    s_waitcnt vmcnt(9)
    v_mfma_f32_16x16x32_bf16 v[36:39], a[124:127], v[28:31], v[36:39]
    v_mul_f32 v120, 0x3b000000, v120
    v_mul_f32 v97, 0x3b000000, v97
    s_waitcnt vmcnt(8)
    v_mfma_f32_16x16x32_bf16 v[40:43], a[188:191], v[28:31], v[40:43]
    v_mul_f32 v105, 0x3b000000, v105
    v_mul_f32 v113, 0x3b000000, v113
    ds_read_b128 v[28:31], v57 offset:192
    s_waitcnt lgkmcnt(3)
    v_mfma_f32_16x16x32_bf16 v[240:243], a[0:3], v[16:19], 0
    v_mul_f32 v121, 0x3b000000, v121
    s_add_u32 s67, s70, 0x1000
    buffer_load_dwordx4 v[144:147], v4, s[4:7], s67 offen offset:0
    v_mfma_f32_16x16x32_bf16 v[244:247], a[64:67], v[16:19], 0
    v_fma_f32 v97, -v96, v96, v97
    v_fma_f32 v105, -v104, v104, v105
    v_fma_f32 v113, -v112, v112, v113
    v_mfma_f32_16x16x32_bf16 v[248:251], a[128:131], v[16:19], 0
    v_fma_f32 v121, -v120, v120, v121
    v_max_f32 v97, 0, v97
    ds_read_b128 v[16:19], v57 offset:256
    s_waitcnt lgkmcnt(3)
    v_mfma_f32_16x16x32_bf16 v[240:243], a[16:19], v[20:23], v[240:243]
    v_max_f32 v105, 0, v105
    v_max_f32 v113, 0, v113
    v_mfma_f32_16x16x32_bf16 v[244:247], a[80:83], v[20:23], v[244:247]
    v_max_f32 v121, 0, v121
    s_add_u32 s67, s70, 0xb000
    buffer_load_dwordx4 v[232:235], v4, s[4:7], s67 offen offset:3072
    v_mfma_f32_16x16x32_bf16 v[248:251], a[144:147], v[20:23], v[248:251]
    v_add_f32 v97, 0x3727c5ac, v97
    v_add_f32 v105, 0x3727c5ac, v105
    ds_read_b128 v[20:23], v57 offset:320
    s_waitcnt lgkmcnt(3)
    v_mfma_f32_16x16x32_bf16 v[240:243], a[32:35], v[24:27], v[240:243]
    v_add_f32 v113, 0x3727c5ac, v113
    v_add_f32 v121, 0x3727c5ac, v121
    v_rsq_f32 v84, v97
    v_mfma_f32_16x16x32_bf16 v[244:247], a[96:99], v[24:27], v[244:247]
    v_rsq_f32 v86, v105
    v_rsq_f32 v88, v113
    v_mfma_f32_16x16x32_bf16 v[248:251], a[160:163], v[24:27], v[248:251]
    v_rsq_f32 v90, v121
    s_add_u32 s67, s70, 0x1000
    buffer_load_dwordx4 v[148:151], v4, s[4:7], s67 offen offset:1024
    ds_read_b128 v[24:27], v57 offset:384
    s_waitcnt lgkmcnt(3)
    v_mfma_f32_16x16x32_bf16 v[240:243], a[48:51], v[28:31], v[240:243]
    v_mul_f32 v85, -v96, v84
    v_mul_f32 v87, -v104, v86
    v_mfma_f32_16x16x32_bf16 v[244:247], a[112:115], v[28:31], v[244:247]
    v_mul_f32 v89, -v112, v88
    v_mul_f32 v91, -v120, v90
    v_mfma_f32_16x16x32_bf16 v[248:251], a[176:179], v[28:31], v[248:251]
    v_mul_f32 v84, s72, v84
    v_mul_f32 v86, s72, v86
    v_mul_f32 v88, s72, v88
    ds_read_b128 v[28:31], v57 offset:448
    s_waitcnt lgkmcnt(3)
    v_mfma_f32_16x16x32_bf16 v[240:243], a[4:7], v[16:19], v[240:243]
    v_mul_f32 v90, s72, v90
    s_add_u32 s67, s70, 0xc000
    buffer_load_dwordx4 v[236:239], v4, s[4:7], s67 offen offset:0
    v_mfma_f32_16x16x32_bf16 v[244:247], a[68:71], v[16:19], v[244:247]
    v_mfma_f32_16x16x32_bf16 v[248:251], a[132:135], v[16:19], v[248:251]
    ds_read_b128 v[16:19], v57 offset:512
    s_waitcnt lgkmcnt(3)
    v_mfma_f32_16x16x32_bf16 v[240:243], a[20:23], v[20:23], v[240:243]
    v_mfma_f32_16x16x32_bf16 v[244:247], a[84:87], v[20:23], v[244:247]
    v_mfma_f32_16x16x32_bf16 v[248:251], a[148:151], v[20:23], v[248:251]
    ds_read_b128 v[20:23], v57 offset:576
    s_waitcnt lgkmcnt(3)
    v_mfma_f32_16x16x32_bf16 v[240:243], a[36:39], v[24:27], v[240:243]
    v_mfma_f32_16x16x32_bf16 v[244:247], a[100:103], v[24:27], v[244:247]
    v_mfma_f32_16x16x32_bf16 v[248:251], a[164:167], v[24:27], v[248:251]
    ds_read_b128 v[24:27], v57 offset:640
    s_waitcnt lgkmcnt(3)
    v_mfma_f32_16x16x32_bf16 v[240:243], a[52:55], v[28:31], v[240:243]
    v_mfma_f32_16x16x32_bf16 v[244:247], a[116:119], v[28:31], v[244:247]
    v_mfma_f32_16x16x32_bf16 v[248:251], a[180:183], v[28:31], v[248:251]
    ds_read_b128 v[28:31], v57 offset:704
    s_waitcnt lgkmcnt(3)
    v_mfma_f32_16x16x32_bf16 v[240:243], a[8:11], v[16:19], v[240:243]
    v_mfma_f32_16x16x32_bf16 v[244:247], a[72:75], v[16:19], v[244:247]
    v_mfma_f32_16x16x32_bf16 v[248:251], a[136:139], v[16:19], v[248:251]
    ds_read_b128 v[16:19], v57 offset:768
    s_waitcnt lgkmcnt(3)
    v_mfma_f32_16x16x32_bf16 v[240:243], a[24:27], v[20:23], v[240:243]
    v_mfma_f32_16x16x32_bf16 v[244:247], a[88:91], v[20:23], v[244:247]
    v_mfma_f32_16x16x32_bf16 v[248:251], a[152:155], v[20:23], v[248:251]
    ds_read_b128 v[20:23], v57 offset:832
    s_waitcnt lgkmcnt(3)
    v_mfma_f32_16x16x32_bf16 v[240:243], a[40:43], v[24:27], v[240:243]
    v_mfma_f32_16x16x32_bf16 v[244:247], a[104:107], v[24:27], v[244:247]
    v_mfma_f32_16x16x32_bf16 v[248:251], a[168:171], v[24:27], v[248:251]
    ds_read_b128 v[24:27], v57 offset:896
    s_waitcnt lgkmcnt(3)
    v_mfma_f32_16x16x32_bf16 v[240:243], a[56:59], v[28:31], v[240:243]
    v_mfma_f32_16x16x32_bf16 v[244:247], a[120:123], v[28:31], v[244:247]
    v_mfma_f32_16x16x32_bf16 v[248:251], a[184:187], v[28:31], v[248:251]
    ds_read_b128 v[28:31], v57 offset:960
    s_waitcnt lgkmcnt(3)
    v_mfma_f32_16x16x32_bf16 v[240:243], a[12:15], v[16:19], v[240:243]
    v_mfma_f32_16x16x32_bf16 v[244:247], a[76:79], v[16:19], v[244:247]
    v_mfma_f32_16x16x32_bf16 v[248:251], a[140:143], v[16:19], v[248:251]
    ds_read_b128 v[16:19], v4 offset:16384
    s_waitcnt lgkmcnt(3)
    v_mfma_f32_16x16x32_bf16 v[240:243], a[28:31], v[20:23], v[240:243]
    v_mfma_f32_16x16x32_bf16 v[244:247], a[92:95], v[20:23], v[244:247]
    v_mfma_f32_16x16x32_bf16 v[248:251], a[156:159], v[20:23], v[248:251]
    ds_read_b128 v[20:23], v4 offset:17408
    s_waitcnt lgkmcnt(3)
    v_mfma_f32_16x16x32_bf16 v[240:243], a[44:47], v[24:27], v[240:243]
    v_mfma_f32_16x16x32_bf16 v[244:247], a[108:111], v[24:27], v[244:247]
    v_mfma_f32_16x16x32_bf16 v[248:251], a[172:175], v[24:27], v[248:251]
    ds_read_b128 v[24:27], v4 offset:18432
    s_waitcnt lgkmcnt(3)
    v_mfma_f32_16x16x32_bf16 v[240:243], a[60:63], v[28:31], v[240:243]
    v_mfma_f32_16x16x32_bf16 v[244:247], a[124:127], v[28:31], v[244:247]
    v_mfma_f32_16x16x32_bf16 v[248:251], a[188:191], v[28:31], v[248:251]
    ds_read_b128 v[28:31], v4 offset:19456
    s_waitcnt lgkmcnt(3)
    v_mfma_f32_16x16x32_bf16 v[44:47], a[0:3], v[16:19], 0
    s_nop 2
    v_mul_f32_dpp v60, v240, v59 quad_perm:[0,0,2,2] row_mask:0xf bank_mask:0xf
    v_mul_f32_dpp v72, v240, v59 quad_perm:[1,1,3,3] row_mask:0xf bank_mask:0xf
    v_mul_f32_dpp v61, v241, v59 quad_perm:[0,0,2,2] row_mask:0xf bank_mask:0xf
    v_mul_f32_dpp v73, v241, v59 quad_perm:[1,1,3,3] row_mask:0xf bank_mask:0xf
    v_mfma_f32_16x16x32_bf16 v[48:51], a[64:67], v[16:19], 0
    v_mul_f32_dpp v62, v242, v59 quad_perm:[0,0,2,2] row_mask:0xf bank_mask:0xf
    v_mul_f32_dpp v74, v242, v59 quad_perm:[1,1,3,3] row_mask:0xf bank_mask:0xf
    v_mfma_f32_16x16x32_bf16 v[52:55], a[128:131], v[16:19], 0
    v_mul_f32_dpp v63, v243, v59 quad_perm:[0,0,2,2] row_mask:0xf bank_mask:0xf
    s_add_u32 s67, s70, 0x1000
    buffer_load_dwordx4 v[152:155], v4, s[4:7], s67 offen offset:2048
    ds_read_b128 v[16:19], v4 offset:20480
    s_waitcnt lgkmcnt(3)
    v_mfma_f32_16x16x32_bf16 v[44:47], a[16:19], v[20:23], v[44:47]
    v_mul_f32_dpp v75, v243, v59 quad_perm:[1,1,3,3] row_mask:0xf bank_mask:0xf
    v_mul_f32_dpp v64, v244, v59 quad_perm:[0,0,2,2] row_mask:0xf bank_mask:0xf
    v_mul_f32_dpp v76, v244, v59 quad_perm:[1,1,3,3] row_mask:0xf bank_mask:0xf
    v_mfma_f32_16x16x32_bf16 v[48:51], a[80:83], v[20:23], v[48:51]
    v_mul_f32_dpp v65, v245, v59 quad_perm:[0,0,2,2] row_mask:0xf bank_mask:0xf
    v_mul_f32_dpp v77, v245, v59 quad_perm:[1,1,3,3] row_mask:0xf bank_mask:0xf
    v_mfma_f32_16x16x32_bf16 v[52:55], a[144:147], v[20:23], v[52:55]
    v_mul_f32_dpp v66, v246, v59 quad_perm:[0,0,2,2] row_mask:0xf bank_mask:0xf
    v_mul_f32_dpp v78, v246, v59 quad_perm:[1,1,3,3] row_mask:0xf bank_mask:0xf
    ds_read_b128 v[20:23], v4 offset:21504
    s_waitcnt lgkmcnt(3)
    v_mfma_f32_16x16x32_bf16 v[44:47], a[32:35], v[24:27], v[44:47]
    s_add_u32 s67, s70, 0xc000
    buffer_load_dwordx4 a[192:195], v4, s[4:7], s67 offen offset:1024
    v_mul_f32_dpp v67, v247, v59 quad_perm:[0,0,2,2] row_mask:0xf bank_mask:0xf
    v_mfma_f32_16x16x32_bf16 v[48:51], a[96:99], v[24:27], v[48:51]
    v_mul_f32_dpp v79, v247, v59 quad_perm:[1,1,3,3] row_mask:0xf bank_mask:0xf
    v_mul_f32_dpp v68, v248, v59 quad_perm:[0,0,2,2] row_mask:0xf bank_mask:0xf
    v_mfma_f32_16x16x32_bf16 v[52:55], a[160:163], v[24:27], v[52:55]
    v_mul_f32_dpp v80, v248, v59 quad_perm:[1,1,3,3] row_mask:0xf bank_mask:0xf
    v_mul_f32_dpp v69, v249, v59 quad_perm:[0,0,2,2] row_mask:0xf bank_mask:0xf
    v_mul_f32_dpp v81, v249, v59 quad_perm:[1,1,3,3] row_mask:0xf bank_mask:0xf
    ds_read_b128 v[24:27], v4 offset:22528
    s_waitcnt lgkmcnt(3)
    v_mfma_f32_16x16x32_bf16 v[44:47], a[48:51], v[28:31], v[44:47]
    v_mul_f32_dpp v70, v250, v59 quad_perm:[0,0,2,2] row_mask:0xf bank_mask:0xf
    s_add_u32 s67, s70, 0x1000
    buffer_load_dwordx4 v[156:159], v4, s[4:7], s67 offen offset:3072
    v_mfma_f32_16x16x32_bf16 v[48:51], a[112:115], v[28:31], v[48:51]
    v_mul_f32_dpp v82, v250, v59 quad_perm:[1,1,3,3] row_mask:0xf bank_mask:0xf
    v_mul_f32_dpp v71, v251, v59 quad_perm:[0,0,2,2] row_mask:0xf bank_mask:0xf
    v_mfma_f32_16x16x32_bf16 v[52:55], a[176:179], v[28:31], v[52:55]
    v_mul_f32_dpp v83, v251, v59 quad_perm:[1,1,3,3] row_mask:0xf bank_mask:0xf
    v_fma_f32 v96, v85, v60, v72
    ds_read_b128 v[28:31], v4 offset:23552
    s_waitcnt lgkmcnt(3)
    v_mfma_f32_16x16x32_bf16 v[44:47], a[4:7], v[16:19], v[44:47]
    v_fma_f32 v97, v85, v61, v73
    v_fma_f32 v98, v85, v62, v74
    v_mfma_f32_16x16x32_bf16 v[48:51], a[68:71], v[16:19], v[48:51]
    v_fma_f32 v99, v85, v63, v75
    s_add_u32 s67, s70, 0xc000
    buffer_load_dwordx4 a[196:199], v4, s[4:7], s67 offen offset:2048
    v_fma_f32 v100, v85, v64, v76
    v_mfma_f32_16x16x32_bf16 v[52:55], a[132:135], v[16:19], v[52:55]
    v_fma_f32 v101, v85, v65, v77
    v_fma_f32 v102, v85, v66, v78
    ds_read_b128 v[16:19], v4 offset:24576
    s_waitcnt lgkmcnt(3)
    v_mfma_f32_16x16x32_bf16 v[44:47], a[20:23], v[20:23], v[44:47]
    v_fma_f32 v103, v85, v67, v79
    v_fma_f32 v104, v85, v68, v80
    v_mfma_f32_16x16x32_bf16 v[48:51], a[84:87], v[20:23], v[48:51]
    v_fma_f32 v105, v85, v69, v81
    v_fma_f32 v106, v85, v70, v82
    v_mfma_f32_16x16x32_bf16 v[52:55], a[148:151], v[20:23], v[52:55]
    s_add_u32 s67, s70, 0x2000
    buffer_load_dwordx4 v[160:163], v4, s[4:7], s67 offen offset:0
    v_fma_f32 v107, v85, v71, v83
    ds_read_b128 v[20:23], v4 offset:25600
    s_waitcnt lgkmcnt(3)
    v_mfma_f32_16x16x32_bf16 v[44:47], a[36:39], v[24:27], v[44:47]
    v_fma_f32 v32, v84, v32, v96
    v_fma_f32 v33, v84, v33, v97
    v_fma_f32 v34, v84, v34, v98
    v_mfma_f32_16x16x32_bf16 v[48:51], a[100:103], v[24:27], v[48:51]
    v_fma_f32 v35, v84, v35, v99
    v_fma_f32 v36, v84, v36, v100
    v_mfma_f32_16x16x32_bf16 v[52:55], a[164:167], v[24:27], v[52:55]
    v_fma_f32 v37, v84, v37, v101
    s_add_u32 s67, s70, 0xc000
    buffer_load_dwordx4 a[200:203], v4, s[4:7], s67 offen offset:3072
    ds_read_b128 v[24:27], v4 offset:26624
    s_waitcnt lgkmcnt(3)
    v_mfma_f32_16x16x32_bf16 v[44:47], a[52:55], v[28:31], v[44:47]
    v_fma_f32 v38, v84, v38, v102
    v_fma_f32 v39, v84, v39, v103
    v_mfma_f32_16x16x32_bf16 v[48:51], a[116:119], v[28:31], v[48:51]
    v_fma_f32 v40, v84, v40, v104
    v_fma_f32 v41, v84, v41, v105
    v_mfma_f32_16x16x32_bf16 v[52:55], a[180:183], v[28:31], v[52:55]
    v_fma_f32 v42, v84, v42, v106
    v_fma_f32 v43, v84, v43, v107
    v_exp_f32 v96, v32
    ds_read_b128 v[28:31], v4 offset:27648
    s_waitcnt lgkmcnt(3)
    v_mfma_f32_16x16x32_bf16 v[44:47], a[8:11], v[16:19], v[44:47]
    s_add_u32 s67, s70, 0x2000
    buffer_load_dwordx4 v[164:167], v4, s[4:7], s67 offen offset:1024
    v_mfma_f32_16x16x32_bf16 v[48:51], a[72:75], v[16:19], v[48:51]
    v_exp_f32 v97, v33
    v_mfma_f32_16x16x32_bf16 v[52:55], a[136:139], v[16:19], v[52:55]
    v_exp_f32 v98, v34
    ds_read_b128 v[16:19], v4 offset:28672
    s_waitcnt lgkmcnt(3)
    v_mfma_f32_16x16x32_bf16 v[44:47], a[24:27], v[20:23], v[44:47]
    v_exp_f32 v99, v35
    v_mfma_f32_16x16x32_bf16 v[48:51], a[88:91], v[20:23], v[48:51]
    v_exp_f32 v100, v36
    v_exp_f32 v101, v37
    v_mfma_f32_16x16x32_bf16 v[52:55], a[152:155], v[20:23], v[52:55]
    v_exp_f32 v102, v38
    ds_read_b128 v[20:23], v4 offset:29696
    s_waitcnt lgkmcnt(3)
    v_mfma_f32_16x16x32_bf16 v[44:47], a[40:43], v[24:27], v[44:47]
    v_exp_f32 v103, v39
    v_mfma_f32_16x16x32_bf16 v[48:51], a[104:107], v[24:27], v[48:51]
    s_add_u32 s67, s70, 0xd000
    buffer_load_dwordx4 a[204:207], v4, s[4:7], s67 offen offset:0
    v_mfma_f32_16x16x32_bf16 v[52:55], a[168:171], v[24:27], v[52:55]
    v_exp_f32 v104, v40
    ds_read_b128 v[24:27], v4 offset:30720
    s_waitcnt lgkmcnt(3)
    v_mfma_f32_16x16x32_bf16 v[44:47], a[56:59], v[28:31], v[44:47]
    v_exp_f32 v105, v41
    v_exp_f32 v106, v42
    v_mfma_f32_16x16x32_bf16 v[48:51], a[120:123], v[28:31], v[48:51]
    v_exp_f32 v107, v43
    v_mfma_f32_16x16x32_bf16 v[52:55], a[184:187], v[28:31], v[52:55]
    v_fma_f32 v96, v96, v59, v59
    ds_read_b128 v[28:31], v4 offset:31744
    s_waitcnt lgkmcnt(3)
    v_mfma_f32_16x16x32_bf16 v[44:47], a[12:15], v[16:19], v[44:47]
    v_fma_f32 v97, v97, v59, v59
    v_fma_f32 v98, v98, v59, v59
    v_mfma_f32_16x16x32_bf16 v[48:51], a[76:79], v[16:19], v[48:51]
    s_add_u32 s67, s70, 0x2000
    buffer_load_dwordx4 v[168:171], v4, s[4:7], s67 offen offset:2048
    v_fma_f32 v99, v99, v59, v59
    v_mfma_f32_16x16x32_bf16 v[52:55], a[140:143], v[16:19], v[52:55]
    v_fma_f32 v100, v100, v59, v59
    v_fma_f32 v101, v101, v59, v59
    v_fma_f32 v102, v102, v59, v59
    ds_read_b128 v[16:19], v4 offset:32768
    s_waitcnt lgkmcnt(3)
    v_mfma_f32_16x16x32_bf16 v[44:47], a[28:31], v[20:23], v[44:47]
    v_fma_f32 v103, v103, v59, v59
    v_fma_f32 v104, v104, v59, v59
    v_mfma_f32_16x16x32_bf16 v[48:51], a[92:95], v[20:23], v[48:51]
    v_fma_f32 v105, v105, v59, v59
    s_add_u32 s67, s70, 0xd000
    buffer_load_dwordx4 a[208:211], v4, s[4:7], s67 offen offset:1024
    v_mfma_f32_16x16x32_bf16 v[52:55], a[156:159], v[20:23], v[52:55]
    v_fma_f32 v106, v106, v59, v59
    v_fma_f32 v107, v107, v59, v59
    ds_read_b128 v[20:23], v4 offset:33792
    s_waitcnt lgkmcnt(3)
    v_mfma_f32_16x16x32_bf16 v[44:47], a[44:47], v[24:27], v[44:47]
    v_rcp_f32 v96, v96
    v_mfma_f32_16x16x32_bf16 v[48:51], a[108:111], v[24:27], v[48:51]
    v_rcp_f32 v97, v97
    v_rcp_f32 v98, v98
    v_mfma_f32_16x16x32_bf16 v[52:55], a[172:175], v[24:27], v[52:55]
    v_rcp_f32 v99, v99
    ds_read_b128 v[24:27], v4 offset:34816
    s_waitcnt lgkmcnt(3)
    v_mfma_f32_16x16x32_bf16 v[44:47], a[60:63], v[28:31], v[44:47]
    v_rcp_f32 v100, v100
    v_mfma_f32_16x16x32_bf16 v[48:51], a[124:127], v[28:31], v[48:51]
    s_add_u32 s67, s70, 0x2000
    buffer_load_dwordx4 v[172:175], v4, s[4:7], s67 offen offset:3072
    v_mfma_f32_16x16x32_bf16 v[52:55], a[188:191], v[28:31], v[52:55]
    v_rcp_f32 v101, v101
    v_rcp_f32 v102, v102
    v_rcp_f32 v103, v103
    v_rcp_f32 v104, v104
    v_rcp_f32 v105, v105
    v_rcp_f32 v106, v106
    v_rcp_f32 v107, v107
    s_add_u32 s67, s70, 0xd000
    buffer_load_dwordx4 a[212:215], v4, s[4:7], s67 offen offset:2048
    v_mul_f32 v96, v96, v32
    v_mul_f32 v97, v97, v33
    v_mul_f32 v98, v98, v34
    v_mul_f32 v99, v99, v35
    v_mul_f32 v100, v100, v36
    v_mul_f32 v101, v101, v37
    v_mul_f32 v102, v102, v38
    v_mul_f32 v103, v103, v39
    v_mul_f32 v104, v104, v40
    v_mul_f32 v105, v105, v41
    v_mul_f32 v106, v106, v42
    v_mul_f32 v107, v107, v43
    v_cvt_pk_bf16_f32 v112, v96, v97
    v_cvt_pk_bf16_f32 v113, v98, v99
    v_cvt_pk_bf16_f32 v116, v100, v101
    v_cvt_pk_bf16_f32 v117, v102, v103
    v_cvt_pk_bf16_f32 v120, v104, v105
    v_cvt_pk_bf16_f32 v121, v106, v107
    ds_read_b128 v[28:31], v4 offset:35840
    s_waitcnt lgkmcnt(3)
    v_mfma_f32_16x16x32_bf16 v[32:35], a[0:3], v[16:19], 0
    v_fma_f32 v96, v87, v60, v72
    v_fma_f32 v97, v87, v61, v73
    v_fma_f32 v98, v87, v62, v74
    v_mfma_f32_16x16x32_bf16 v[36:39], a[64:67], v[16:19], 0
    v_fma_f32 v99, v87, v63, v75
    v_fma_f32 v100, v87, v64, v76
    v_mfma_f32_16x16x32_bf16 v[40:43], a[128:131], v[16:19], 0
    v_fma_f32 v101, v87, v65, v77
    v_fma_f32 v102, v87, v66, v78
    ds_read_b128 v[16:19], v4 offset:36864
    s_waitcnt lgkmcnt(3)
    v_mfma_f32_16x16x32_bf16 v[32:35], a[16:19], v[20:23], v[32:35]
    s_add_u32 s67, s70, 0x3000
    buffer_load_dwordx4 v[176:179], v4, s[4:7], s67 offen offset:0
    v_fma_f32 v103, v87, v67, v79
    v_mfma_f32_16x16x32_bf16 v[36:39], a[80:83], v[20:23], v[36:39]
    v_fma_f32 v104, v87, v68, v80
    v_fma_f32 v105, v87, v69, v81
    v_mfma_f32_16x16x32_bf16 v[40:43], a[144:147], v[20:23], v[40:43]
    v_fma_f32 v106, v87, v70, v82
    v_fma_f32 v107, v87, v71, v83
    v_fma_f32 v44, v86, v44, v96
    ds_read_b128 v[20:23], v4 offset:37888
    s_waitcnt lgkmcnt(3)
    v_mfma_f32_16x16x32_bf16 v[32:35], a[32:35], v[24:27], v[32:35]
    v_fma_f32 v45, v86, v45, v97
    s_add_u32 s67, s70, 0xd000
    buffer_load_dwordx4 a[216:219], v4, s[4:7], s67 offen offset:3072
    v_mfma_f32_16x16x32_bf16 v[36:39], a[96:99], v[24:27], v[36:39]
    v_fma_f32 v46, v86, v46, v98
    v_fma_f32 v47, v86, v47, v99
    v_mfma_f32_16x16x32_bf16 v[40:43], a[160:163], v[24:27], v[40:43]
    v_fma_f32 v48, v86, v48, v100
    v_fma_f32 v49, v86, v49, v101
    ds_read_b128 v[24:27], v4 offset:38912
    s_waitcnt lgkmcnt(3)
    v_mfma_f32_16x16x32_bf16 v[32:35], a[48:51], v[28:31], v[32:35]
    v_fma_f32 v50, v86, v50, v102
    v_fma_f32 v51, v86, v51, v103
    v_mfma_f32_16x16x32_bf16 v[36:39], a[112:115], v[28:31], v[36:39]
    v_fma_f32 v52, v86, v52, v104
    s_add_u32 s67, s70, 0x3000
    buffer_load_dwordx4 v[180:183], v4, s[4:7], s67 offen offset:1024
    v_fma_f32 v53, v86, v53, v105
    v_mfma_f32_16x16x32_bf16 v[40:43], a[176:179], v[28:31], v[40:43]
    v_fma_f32 v54, v86, v54, v106
    v_fma_f32 v55, v86, v55, v107
    ds_read_b128 v[28:31], v4 offset:39936
    s_waitcnt lgkmcnt(3)
    v_mfma_f32_16x16x32_bf16 v[32:35], a[4:7], v[16:19], v[32:35]
    v_exp_f32 v96, v44
    v_mfma_f32_16x16x32_bf16 v[36:39], a[68:71], v[16:19], v[36:39]
    v_exp_f32 v97, v45
    v_mfma_f32_16x16x32_bf16 v[40:43], a[132:135], v[16:19], v[40:43]
    v_exp_f32 v98, v46
    ds_read_b128 v[16:19], v4 offset:40960
    s_waitcnt lgkmcnt(3)
    v_mfma_f32_16x16x32_bf16 v[32:35], a[20:23], v[20:23], v[32:35]
    v_exp_f32 v99, v47
    s_add_u32 s67, s70, 0xe000
    buffer_load_dwordx4 a[220:223], v4, s[4:7], s67 offen offset:0
    v_mfma_f32_16x16x32_bf16 v[36:39], a[84:87], v[20:23], v[36:39]
    v_exp_f32 v100, v48
    v_mfma_f32_16x16x32_bf16 v[40:43], a[148:151], v[20:23], v[40:43]
    v_exp_f32 v101, v49
    ds_read_b128 v[20:23], v4 offset:41984
    s_waitcnt lgkmcnt(3)
    v_mfma_f32_16x16x32_bf16 v[32:35], a[36:39], v[24:27], v[32:35]
    v_exp_f32 v102, v50
    v_mfma_f32_16x16x32_bf16 v[36:39], a[100:103], v[24:27], v[36:39]
    v_exp_f32 v103, v51
    v_mfma_f32_16x16x32_bf16 v[40:43], a[164:167], v[24:27], v[40:43]
    v_exp_f32 v104, v52
    v_exp_f32 v105, v53
    ds_read_b128 v[24:27], v4 offset:43008
    s_waitcnt lgkmcnt(3)
    v_mfma_f32_16x16x32_bf16 v[32:35], a[52:55], v[28:31], v[32:35]
    v_exp_f32 v106, v54
    v_mfma_f32_16x16x32_bf16 v[36:39], a[116:119], v[28:31], v[36:39]
    s_add_u32 s67, s70, 0x3000
    buffer_load_dwordx4 v[184:187], v4, s[4:7], s67 offen offset:2048
    v_mfma_f32_16x16x32_bf16 v[40:43], a[180:183], v[28:31], v[40:43]
    v_exp_f32 v107, v55
    ds_read_b128 v[28:31], v4 offset:44032
    s_waitcnt lgkmcnt(3)
    v_mfma_f32_16x16x32_bf16 v[32:35], a[8:11], v[16:19], v[32:35]
    v_fma_f32 v96, v96, v59, v59
    v_fma_f32 v97, v97, v59, v59
    v_mfma_f32_16x16x32_bf16 v[36:39], a[72:75], v[16:19], v[36:39]
    v_fma_f32 v98, v98, v59, v59
    v_fma_f32 v99, v99, v59, v59
    v_fma_f32 v100, v100, v59, v59
    v_mfma_f32_16x16x32_bf16 v[40:43], a[136:139], v[16:19], v[40:43]
    v_fma_f32 v101, v101, v59, v59
    s_add_u32 s67, s70, 0xe000
    buffer_load_dwordx4 a[224:227], v4, s[4:7], s67 offen offset:1024
    ds_read_b128 v[16:19], v4 offset:45056
    s_waitcnt lgkmcnt(3)
    v_mfma_f32_16x16x32_bf16 v[32:35], a[24:27], v[20:23], v[32:35]
    v_fma_f32 v102, v102, v59, v59
    v_fma_f32 v103, v103, v59, v59
    v_mfma_f32_16x16x32_bf16 v[36:39], a[88:91], v[20:23], v[36:39]
    v_fma_f32 v104, v104, v59, v59
    v_fma_f32 v105, v105, v59, v59
    v_mfma_f32_16x16x32_bf16 v[40:43], a[152:155], v[20:23], v[40:43]
    v_fma_f32 v106, v106, v59, v59
    v_fma_f32 v107, v107, v59, v59
    ds_read_b128 v[20:23], v4 offset:46080
    s_waitcnt lgkmcnt(3)
    v_mfma_f32_16x16x32_bf16 v[32:35], a[40:43], v[24:27], v[32:35]
    v_rcp_f32 v96, v96
    s_add_u32 s67, s70, 0x3000
    buffer_load_dwordx4 v[188:191], v4, s[4:7], s67 offen offset:3072
    v_mfma_f32_16x16x32_bf16 v[36:39], a[104:107], v[24:27], v[36:39]
    v_rcp_f32 v97, v97
    v_mfma_f32_16x16x32_bf16 v[40:43], a[168:171], v[24:27], v[40:43]
    v_rcp_f32 v98, v98
    ds_read_b128 v[24:27], v4 offset:47104
    s_waitcnt lgkmcnt(3)
    v_mfma_f32_16x16x32_bf16 v[32:35], a[56:59], v[28:31], v[32:35]
    v_rcp_f32 v99, v99
    v_mfma_f32_16x16x32_bf16 v[36:39], a[120:123], v[28:31], v[36:39]
    v_rcp_f32 v100, v100
    v_mfma_f32_16x16x32_bf16 v[40:43], a[184:187], v[28:31], v[40:43]
    v_rcp_f32 v101, v101
    v_rcp_f32 v102, v102
    ds_read_b128 v[28:31], v4 offset:48128
    s_waitcnt lgkmcnt(3)
    v_mfma_f32_16x16x32_bf16 v[32:35], a[12:15], v[16:19], v[32:35]
    v_rcp_f32 v103, v103
    v_mfma_f32_16x16x32_bf16 v[36:39], a[76:79], v[16:19], v[36:39]
    s_add_u32 s67, s70, 0xe000
    buffer_load_dwordx4 a[228:231], v4, s[4:7], s67 offen offset:2048
    v_mfma_f32_16x16x32_bf16 v[40:43], a[140:143], v[16:19], v[40:43]
    v_rcp_f32 v104, v104
    ds_read_b128 v[16:19], v4 offset:49152
    s_waitcnt lgkmcnt(3)
    v_mfma_f32_16x16x32_bf16 v[32:35], a[28:31], v[20:23], v[32:35]
    v_rcp_f32 v105, v105
    v_mfma_f32_16x16x32_bf16 v[36:39], a[92:95], v[20:23], v[36:39]
    v_rcp_f32 v106, v106
    v_rcp_f32 v107, v107
    v_mfma_f32_16x16x32_bf16 v[40:43], a[156:159], v[20:23], v[40:43]
    v_mul_f32 v96, v96, v44
    ds_read_b128 v[20:23], v4 offset:50176
    s_waitcnt lgkmcnt(3)
    v_mfma_f32_16x16x32_bf16 v[32:35], a[44:47], v[24:27], v[32:35]
    v_mul_f32 v97, v97, v45
    v_mul_f32 v98, v98, v46
    v_mfma_f32_16x16x32_bf16 v[36:39], a[108:111], v[24:27], v[36:39]
    s_add_u32 s67, s70, 0x4000
    buffer_load_dwordx4 v[192:195], v4, s[4:7], s67 offen offset:0
    v_mul_f32 v99, v99, v47
    v_mfma_f32_16x16x32_bf16 v[40:43], a[172:175], v[24:27], v[40:43]
    v_mul_f32 v100, v100, v48
    v_mul_f32 v101, v101, v49
    ds_read_b128 v[24:27], v4 offset:51200
    s_waitcnt lgkmcnt(3)
    v_mfma_f32_16x16x32_bf16 v[32:35], a[60:63], v[28:31], v[32:35]
    v_mul_f32 v102, v102, v50
    v_mul_f32 v103, v103, v51
    v_mul_f32 v104, v104, v52
    v_mfma_f32_16x16x32_bf16 v[36:39], a[124:127], v[28:31], v[36:39]
    v_mul_f32 v105, v105, v53
    s_add_u32 s67, s70, 0xe000
    buffer_load_dwordx4 a[232:235], v4, s[4:7], s67 offen offset:3072
    v_mfma_f32_16x16x32_bf16 v[40:43], a[188:191], v[28:31], v[40:43]
    v_mul_f32 v106, v106, v54
    v_mul_f32 v107, v107, v55
    v_cvt_pk_bf16_f32 v114, v96, v97
    v_cvt_pk_bf16_f32 v115, v98, v99
    v_cvt_pk_bf16_f32 v118, v100, v101
    v_cvt_pk_bf16_f32 v119, v102, v103
    v_cvt_pk_bf16_f32 v122, v104, v105
    v_cvt_pk_bf16_f32 v123, v106, v107
    v_permlane16_swap_b32 v112, v114
    v_permlane16_swap_b32 v113, v115
    v_permlane16_swap_b32 v116, v118
    v_permlane16_swap_b32 v117, v119
    v_permlane16_swap_b32 v120, v122
    v_permlane16_swap_b32 v121, v123
    buffer_store_dwordx4 v[112:115], v56, s[4:7], s71 offen offset:0 sc1
    buffer_store_dwordx4 v[116:119], v56, s[4:7], s71 offen offset:512 sc1
    buffer_store_dwordx4 v[120:123], v56, s[4:7], s71 offen offset:1024 sc1
    s_nop 1
    s_add_u32 s71, s71, 0x15800
    ds_read_b128 v[28:31], v4 offset:52224
    s_waitcnt lgkmcnt(3)
    v_mfma_f32_16x16x32_bf16 v[44:47], a[0:3], v[16:19], 0
    v_lshlrev_b32 v5, 5, v3
    s_lshl_b32 s58, s53, 8
    s_lshl_b32 s59, s55, 7
    s_add_u32 s58, s58, s59
    s_add_u32 s58, s58, 0x6800
    buffer_load_dwordx4 v[240:243], v5, s[4:7], s58 offen sc1
    buffer_load_dwordx4 v[244:247], v5, s[4:7], s58 offen offset:16 sc1
    v_mfma_f32_16x16x32_bf16 v[48:51], a[64:67], v[16:19], 0
    v_mfma_f32_16x16x32_bf16 v[52:55], a[128:131], v[16:19], 0
    v_fma_f32 v96, v89, v60, v72
    v_fma_f32 v97, v89, v61, v73
    v_fma_f32 v98, v89, v62, v74
    ds_read_b128 v[16:19], v4 offset:53248
    s_waitcnt lgkmcnt(3)
    v_mfma_f32_16x16x32_bf16 v[44:47], a[16:19], v[20:23], v[44:47]
    v_fma_f32 v99, v89, v63, v75
    v_fma_f32 v100, v89, v64, v76
    v_mfma_f32_16x16x32_bf16 v[48:51], a[80:83], v[20:23], v[48:51]
    s_add_u32 s67, s70, 0x4000
    buffer_load_dwordx4 v[196:199], v4, s[4:7], s67 offen offset:1024
    v_fma_f32 v101, v89, v65, v77
    v_mfma_f32_16x16x32_bf16 v[52:55], a[144:147], v[20:23], v[52:55]
    v_fma_f32 v102, v89, v66, v78
    v_fma_f32 v103, v89, v67, v79
    ds_read_b128 v[20:23], v4 offset:54272
    s_waitcnt lgkmcnt(3)
    v_mfma_f32_16x16x32_bf16 v[44:47], a[32:35], v[24:27], v[44:47]
    v_fma_f32 v104, v89, v68, v80
    v_fma_f32 v105, v89, v69, v81
    v_mfma_f32_16x16x32_bf16 v[48:51], a[96:99], v[24:27], v[48:51]
    v_fma_f32 v106, v89, v70, v82
    s_add_u32 s67, s70, 0xf000
    buffer_load_dwordx4 a[236:239], v4, s[4:7], s67 offen offset:0
    v_fma_f32 v107, v89, v71, v83
    v_mfma_f32_16x16x32_bf16 v[52:55], a[160:163], v[24:27], v[52:55]
    v_fma_f32 v32, v88, v32, v96
    v_fma_f32 v33, v88, v33, v97
    ds_read_b128 v[24:27], v4 offset:55296
    s_waitcnt lgkmcnt(3)
    v_mfma_f32_16x16x32_bf16 v[44:47], a[48:51], v[28:31], v[44:47]
    v_fma_f32 v34, v88, v34, v98
    v_fma_f32 v35, v88, v35, v99
    v_mfma_f32_16x16x32_bf16 v[48:51], a[112:115], v[28:31], v[48:51]
    v_fma_f32 v36, v88, v36, v100
    s_add_u32 s67, s70, 0x4000
    buffer_load_dwordx4 v[200:203], v4, s[4:7], s67 offen offset:2048
    v_mfma_f32_16x16x32_bf16 v[52:55], a[176:179], v[28:31], v[52:55]
    v_fma_f32 v37, v88, v37, v101
    v_fma_f32 v38, v88, v38, v102
    ds_read_b128 v[28:31], v4 offset:56320
    s_waitcnt lgkmcnt(3)
    v_mfma_f32_16x16x32_bf16 v[44:47], a[4:7], v[16:19], v[44:47]
    v_fma_f32 v39, v88, v39, v103
    v_fma_f32 v40, v88, v40, v104
    v_fma_f32 v41, v88, v41, v105
    v_mfma_f32_16x16x32_bf16 v[48:51], a[68:71], v[16:19], v[48:51]
    v_fma_f32 v42, v88, v42, v106
    s_add_u32 s67, s70, 0xf000
    buffer_load_dwordx4 a[240:243], v4, s[4:7], s67 offen offset:1024
    v_mfma_f32_16x16x32_bf16 v[52:55], a[132:135], v[16:19], v[52:55]
    v_fma_f32 v43, v88, v43, v107
    v_exp_f32 v96, v32
    ds_read_b128 v[16:19], v4 offset:57344
    s_waitcnt lgkmcnt(3)
    v_mfma_f32_16x16x32_bf16 v[44:47], a[20:23], v[20:23], v[44:47]
    v_exp_f32 v97, v33
    v_mfma_f32_16x16x32_bf16 v[48:51], a[84:87], v[20:23], v[48:51]
    v_exp_f32 v98, v34
    v_mfma_f32_16x16x32_bf16 v[52:55], a[148:151], v[20:23], v[52:55]
    v_exp_f32 v99, v35
    ds_read_b128 v[20:23], v4 offset:58368
    s_waitcnt lgkmcnt(3)
    v_mfma_f32_16x16x32_bf16 v[44:47], a[36:39], v[24:27], v[44:47]
    v_exp_f32 v100, v36
    v_mfma_f32_16x16x32_bf16 v[48:51], a[100:103], v[24:27], v[48:51]
    s_add_u32 s67, s70, 0x4000
    buffer_load_dwordx4 v[204:207], v4, s[4:7], s67 offen offset:3072
    v_exp_f32 v101, v37
    v_mfma_f32_16x16x32_bf16 v[52:55], a[164:167], v[24:27], v[52:55]
    v_exp_f32 v102, v38
    ds_read_b128 v[24:27], v4 offset:59392
    s_waitcnt lgkmcnt(3)
    v_mfma_f32_16x16x32_bf16 v[44:47], a[52:55], v[28:31], v[44:47]
    v_exp_f32 v103, v39
    v_mfma_f32_16x16x32_bf16 v[48:51], a[116:119], v[28:31], v[48:51]
    v_exp_f32 v104, v40
    v_mfma_f32_16x16x32_bf16 v[52:55], a[180:183], v[28:31], v[52:55]
    v_exp_f32 v105, v41
    ds_read_b128 v[28:31], v4 offset:60416
    s_waitcnt lgkmcnt(3)
    v_mfma_f32_16x16x32_bf16 v[44:47], a[8:11], v[16:19], v[44:47]
    v_exp_f32 v106, v42
    v_mfma_f32_16x16x32_bf16 v[48:51], a[72:75], v[16:19], v[48:51]
    s_add_u32 s67, s70, 0xf000
    buffer_load_dwordx4 a[244:247], v4, s[4:7], s67 offen offset:2048
    v_exp_f32 v107, v43
    v_mfma_f32_16x16x32_bf16 v[52:55], a[136:139], v[16:19], v[52:55]
    v_fma_f32 v96, v96, v59, v59
    ds_read_b128 v[16:19], v4 offset:61440
    s_waitcnt lgkmcnt(3)
    v_mfma_f32_16x16x32_bf16 v[44:47], a[24:27], v[20:23], v[44:47]
    v_fma_f32 v97, v97, v59, v59
    v_fma_f32 v98, v98, v59, v59
    v_fma_f32 v99, v99, v59, v59
    v_mfma_f32_16x16x32_bf16 v[48:51], a[88:91], v[20:23], v[48:51]
    v_fma_f32 v100, v100, v59, v59
    s_add_u32 s67, s70, 0x5000
    buffer_load_dwordx4 v[208:211], v4, s[4:7], s67 offen offset:0
    v_mfma_f32_16x16x32_bf16 v[52:55], a[152:155], v[20:23], v[52:55]
    s_lshl_b32 s58, s52, 12
    s_lshl_b32 s59, s53, 2
    s_add_u32 s58, s58, s59
    s_add_u32 s58, s58, 0x140000
    v_mov_b32 v5, s38
    v_lshlrev_b32 v6, 6, v1
    s_waitcnt vmcnt(9)
    s_waitcnt lgkmcnt(0)
    s_barrier
    s_and_b64 exec, s[34:35], s[100:101]
    buffer_store_dword v5, v6, s[4:7], s58 offen
    s_andn2_b64 exec, s[100:101], s[34:35]
    buffer_store_dword v5, v6, s[4:7], s58 offen sc1
    s_mov_b64 exec, -1
    ds_read_b128 v[20:23], v4 offset:62464
    v_mfma_f32_16x16x32_bf16 v[44:47], a[40:43], v[24:27], v[44:47]
    v_mfma_f32_16x16x32_bf16 v[48:51], a[104:107], v[24:27], v[48:51]
    v_mfma_f32_16x16x32_bf16 v[52:55], a[168:171], v[24:27], v[52:55]
    v_fma_f32 v101, v101, v59, v59
    ds_read_b128 v[24:27], v4 offset:63488
    v_mfma_f32_16x16x32_bf16 v[44:47], a[56:59], v[28:31], v[44:47]
    v_fma_f32 v102, v102, v59, v59
    v_fma_f32 v103, v103, v59, v59
    v_mfma_f32_16x16x32_bf16 v[48:51], a[120:123], v[28:31], v[48:51]
    v_fma_f32 v104, v104, v59, v59
    v_fma_f32 v105, v105, v59, v59
    v_mfma_f32_16x16x32_bf16 v[52:55], a[184:187], v[28:31], v[52:55]
    v_fma_f32 v106, v106, v59, v59
    s_add_u32 s67, s70, 0xf000
    buffer_load_dwordx4 a[248:251], v4, s[4:7], s67 offen offset:3072
    ds_read_b128 v[28:31], v4 offset:64512
    v_mfma_f32_16x16x32_bf16 v[44:47], a[12:15], v[16:19], v[44:47]
    v_fma_f32 v107, v107, v59, v59
    v_rcp_f32 v96, v96
    v_mfma_f32_16x16x32_bf16 v[48:51], a[76:79], v[16:19], v[48:51]
    v_rcp_f32 v97, v97
    v_mfma_f32_16x16x32_bf16 v[52:55], a[140:143], v[16:19], v[52:55]
    v_rcp_f32 v98, v98
    s_waitcnt lgkmcnt(2)
    v_mfma_f32_16x16x32_bf16 v[44:47], a[28:31], v[20:23], v[44:47]
    v_rcp_f32 v99, v99
    v_mfma_f32_16x16x32_bf16 v[48:51], a[92:95], v[20:23], v[48:51]
    v_rcp_f32 v100, v100
    v_mfma_f32_16x16x32_bf16 v[52:55], a[156:159], v[20:23], v[52:55]
    s_add_u32 s67, s70, 0x5000
    buffer_load_dwordx4 v[212:215], v4, s[4:7], s67 offen offset:1024
    v_rcp_f32 v101, v101
    s_waitcnt lgkmcnt(1)
    v_mfma_f32_16x16x32_bf16 v[44:47], a[44:47], v[24:27], v[44:47]
    v_rcp_f32 v102, v102
    v_mfma_f32_16x16x32_bf16 v[48:51], a[108:111], v[24:27], v[48:51]
    v_rcp_f32 v103, v103
    v_mfma_f32_16x16x32_bf16 v[52:55], a[172:175], v[24:27], v[52:55]
    v_rcp_f32 v104, v104
    s_waitcnt lgkmcnt(0)
    v_mfma_f32_16x16x32_bf16 v[44:47], a[60:63], v[28:31], v[44:47]
    v_rcp_f32 v105, v105
    v_mfma_f32_16x16x32_bf16 v[48:51], a[124:127], v[28:31], v[48:51]
    v_rcp_f32 v106, v106
    v_mfma_f32_16x16x32_bf16 v[52:55], a[188:191], v[28:31], v[52:55]
    s_add_u32 s67, s70, 0x10000
    buffer_load_dwordx4 a[252:255], v4, s[4:7], s67 offen offset:0
    v_rcp_f32 v107, v107
    v_mul_f32 v96, v96, v32
    v_mul_f32 v97, v97, v33
    v_mul_f32 v98, v98, v34
    v_mul_f32 v99, v99, v35
    v_mul_f32 v100, v100, v36
    v_mul_f32 v101, v101, v37
    v_mul_f32 v102, v102, v38
    v_mul_f32 v103, v103, v39
    v_mul_f32 v104, v104, v40
    v_mul_f32 v105, v105, v41
    v_mul_f32 v106, v106, v42
    v_mul_f32 v107, v107, v43
    v_cvt_pk_bf16_f32 v112, v96, v97
    v_cvt_pk_bf16_f32 v113, v98, v99
    v_cvt_pk_bf16_f32 v116, v100, v101
    v_cvt_pk_bf16_f32 v117, v102, v103
    v_cvt_pk_bf16_f32 v120, v104, v105
    v_cvt_pk_bf16_f32 v121, v106, v107
    v_pk_fma_f32 v[96:97], v[90:91], v[60:61], v[72:73] op_sel:[1,0,0] op_sel_hi:[1,1,1]
    v_pk_fma_f32 v[98:99], v[90:91], v[62:63], v[74:75] op_sel:[1,0,0] op_sel_hi:[1,1,1]
    v_pk_fma_f32 v[100:101], v[90:91], v[64:65], v[76:77] op_sel:[1,0,0] op_sel_hi:[1,1,1]
    v_pk_fma_f32 v[102:103], v[90:91], v[66:67], v[78:79] op_sel:[1,0,0] op_sel_hi:[1,1,1]
    v_pk_fma_f32 v[104:105], v[90:91], v[68:69], v[80:81] op_sel:[1,0,0] op_sel_hi:[1,1,1]
    v_pk_fma_f32 v[106:107], v[90:91], v[70:71], v[82:83] op_sel:[1,0,0] op_sel_hi:[1,1,1]
    v_pk_fma_f32 v[44:45], v[90:91], v[44:45], v[96:97] op_sel:[0,0,0] op_sel_hi:[0,1,1]
    v_pk_fma_f32 v[46:47], v[90:91], v[46:47], v[98:99] op_sel:[0,0,0] op_sel_hi:[0,1,1]
    v_pk_fma_f32 v[48:49], v[90:91], v[48:49], v[100:101] op_sel:[0,0,0] op_sel_hi:[0,1,1]
    v_pk_fma_f32 v[50:51], v[90:91], v[50:51], v[102:103] op_sel:[0,0,0] op_sel_hi:[0,1,1]
    v_pk_fma_f32 v[52:53], v[90:91], v[52:53], v[104:105] op_sel:[0,0,0] op_sel_hi:[0,1,1]
    v_pk_fma_f32 v[54:55], v[90:91], v[54:55], v[106:107] op_sel:[0,0,0] op_sel_hi:[0,1,1]
    v_exp_f32 v96, v44
    v_exp_f32 v97, v45
    v_exp_f32 v98, v46
    v_exp_f32 v99, v47
    v_exp_f32 v100, v48
    v_exp_f32 v101, v49
    v_exp_f32 v102, v50
    v_exp_f32 v103, v51
    v_exp_f32 v104, v52
    v_exp_f32 v105, v53
    v_exp_f32 v106, v54
    v_exp_f32 v107, v55
    v_pk_fma_f32 v[96:97], v[96:97], v[58:59], v[58:59] op_sel:[0,1,1] op_sel_hi:[1,1,1]
    v_pk_fma_f32 v[98:99], v[98:99], v[58:59], v[58:59] op_sel:[0,1,1] op_sel_hi:[1,1,1]
    v_pk_fma_f32 v[100:101], v[100:101], v[58:59], v[58:59] op_sel:[0,1,1] op_sel_hi:[1,1,1]
    v_pk_fma_f32 v[102:103], v[102:103], v[58:59], v[58:59] op_sel:[0,1,1] op_sel_hi:[1,1,1]
    v_pk_fma_f32 v[104:105], v[104:105], v[58:59], v[58:59] op_sel:[0,1,1] op_sel_hi:[1,1,1]
    v_pk_fma_f32 v[106:107], v[106:107], v[58:59], v[58:59] op_sel:[0,1,1] op_sel_hi:[1,1,1]
    v_rcp_f32 v96, v96
    v_rcp_f32 v97, v97
    v_rcp_f32 v98, v98
    v_rcp_f32 v99, v99
    v_rcp_f32 v100, v100
    v_rcp_f32 v101, v101
    v_rcp_f32 v102, v102
    v_rcp_f32 v103, v103
    v_rcp_f32 v104, v104
    v_rcp_f32 v105, v105
    v_rcp_f32 v106, v106
    v_rcp_f32 v107, v107
    v_pk_mul_f32 v[96:97], v[96:97], v[44:45]
    v_pk_mul_f32 v[98:99], v[98:99], v[46:47]
    v_pk_mul_f32 v[100:101], v[100:101], v[48:49]
    v_pk_mul_f32 v[102:103], v[102:103], v[50:51]
    v_pk_mul_f32 v[104:105], v[104:105], v[52:53]
    v_pk_mul_f32 v[106:107], v[106:107], v[54:55]
    v_cvt_pk_bf16_f32 v114, v96, v97
    v_cvt_pk_bf16_f32 v115, v98, v99
    s_cmp_eq_u32 s3, 3
    s_cbranch_scc0 L_arm_24
    s_lshl_b32 s20, s52, 12
    s_lshl_b32 s21, s53, 9
    s_add_u32 s20, s20, s21
    s_add_u32 s20, s20, 0x140000
    s_cmp_eq_u32 s34, 0
    s_cbranch_scc1 L_as_25
    s_load_dwordx8 s[24:31], s[36:37], s20
    s_branch L_arm_24
L_as_25:
    s_load_dwordx8 s[24:31], s[36:37], s20 glc
L_arm_24:
    v_cvt_pk_bf16_f32 v118, v100, v101
    v_cvt_pk_bf16_f32 v119, v102, v103
    v_cvt_pk_bf16_f32 v122, v104, v105
    v_cvt_pk_bf16_f32 v123, v106, v107
    v_permlane16_swap_b32 v112, v114
    v_permlane16_swap_b32 v113, v115
    v_permlane16_swap_b32 v116, v118
    v_permlane16_swap_b32 v117, v119
    v_permlane16_swap_b32 v120, v122
    v_permlane16_swap_b32 v121, v123
    buffer_store_dwordx4 v[112:115], v56, s[4:7], s71 offen offset:0 sc1
    buffer_store_dwordx4 v[116:119], v56, s[4:7], s71 offen offset:512 sc1
    buffer_store_dwordx4 v[120:123], v56, s[4:7], s71 offen offset:1024 sc1
    s_mov_b32 s12, s32
    s_and_b32 s13, s33, 0xffff
    s_mov_b32 s14, 0x200000
    s_mov_b32 s15, 0x00020000
    s_mul_i32 s72, s3, 11
    s_min_u32 s72, s72, 32
    s_lshl_b32 s72, s72, 10
    s_mul_i32 s73, s52, 0x2b000
    s_add_u32 s73, s73, s72
    s_add_u32 s73, s73, 0xa00000
    s_mul_i32 s58, s54, 22528
    v_add_u32 v108, s58, v4
    v_add_u32 v109, 0xac00, v108
    v_add_u32 v110, 0x15800, v108
    s_waitcnt vmcnt(15)
    s_mov_b32 s68, s39
    s_branch L_cc_27
L_cp_26:
    s_sleep 8
    v_lshlrev_b32 v5, 5, v3
    s_lshl_b32 s58, s53, 8
    s_lshl_b32 s59, s55, 7
    s_add_u32 s58, s58, s59
    s_add_u32 s58, s58, 0x6800
    buffer_load_dwordx4 v[240:243], v5, s[4:7], s58 offen sc1
    buffer_load_dwordx4 v[244:247], v5, s[4:7], s58 offen offset:16 sc1
    s_waitcnt vmcnt(0)
L_cc_27:
    v_mov_b32 v16, s38
    v_mov_b32 v17, s38
    v_min3_u32 v16, v16, v241, v243
    v_max3_u32 v17, v17, v241, v243
    v_min3_u32 v16, v16, v245, v247
    v_max3_u32 v17, v17, v245, v247
    v_cmp_ne_u32 vcc, v16, v17
    s_add_u32 s68, s68, 1
    s_cbranch_vccz L_pdone_28
    s_cmp_lt_u32 s68, 20000
    s_cbranch_scc1 L_cp_26
    s_mov_b32 s39, 20000
L_pdone_28:
    v_and_b32 v241, 0xffff0000, v240
    v_lshlrev_b32 v240, 16, v240
    v_and_b32 v243, 0xffff0000, v242
    v_lshlrev_b32 v242, 16, v242
    v_and_b32 v245, 0xffff0000, v244
    v_lshlrev_b32 v244, 16, v244
    v_and_b32 v247, 0xffff0000, v246
    v_lshlrev_b32 v246, 16, v246
    s_cmp_eq_u32 s3, 3
    s_cbranch_scc0 L_w3_29
    s_mov_b32 s68, s39
    s_branch L_pq_32
L_poll_30:
    s_min_u32 s21, s68, 7
    s_lshl_b32 s21, s21, 6
    s_add_u32 s21, s20, s21
    s_and_b32 s24, s34, 8
    s_cmp_lt_u32 s68, s24
    s_cbranch_scc0 L_ps_31
    s_load_dwordx8 s[24:31], s[36:37], s21
    s_branch L_pq_32
L_ps_31:
    s_load_dwordx8 s[24:31], s[36:37], s21 glc
L_pq_32:
    s_waitcnt lgkmcnt(0)
    s_xor_b32 s24, s24, s38
    s_xor_b32 s25, s25, s38
    s_xor_b32 s26, s26, s38
    s_xor_b32 s27, s27, s38
    s_xor_b32 s28, s28, s38
    s_xor_b32 s29, s29, s38
    s_xor_b32 s30, s30, s38
    s_xor_b32 s31, s31, s38
    s_or_b32 s24, s24, s25
    s_or_b32 s26, s26, s27
    s_or_b32 s28, s28, s29
    s_or_b32 s30, s30, s31
    s_or_b32 s24, s24, s26
    s_or_b32 s28, s28, s30
    s_or_b32 s24, s24, s28
    s_add_u32 s68, s68, 1
    s_cmp_eq_u32 s24, 0
    s_cbranch_scc1 L_pdone_33
    s_cmp_lt_u32 s68, 20000
    s_cbranch_scc1 L_poll_30
    s_mov_b32 s39, 20000
L_pdone_33:
    s_waitcnt lgkmcnt(0)
L_w3_29:
    s_barrier
    s_add_u32 s74, s73, 0x0
    s_add_u32 m0, s72, 0x0
    s_nop 0
    buffer_load_dwordx4 v4, s[4:7], s74 offen offset:0 sc1 lds
    buffer_load_dwordx4 v4, s[4:7], s74 offen offset:1024 sc1 lds
    buffer_load_dwordx4 v4, s[4:7], s74 offen offset:2048 sc1 lds
    buffer_load_dwordx4 v4, s[4:7], s74 offen offset:3072 sc1 lds
    s_lshl_b32 s58, s52, 12
    s_lshl_b32 s59, s53, 2
    s_add_u32 s58, s58, s59
    s_add_u32 s58, s58, 0x160000
    v_mov_b32 v5, s38
    v_lshlrev_b32 v6, 6, v1
    s_waitcnt vmcnt(4)
    s_barrier
    s_and_b64 exec, s[34:35], s[100:101]
    buffer_store_dword v5, v6, s[4:7], s58 offen
    s_andn2_b64 exec, s[100:101], s[34:35]
    buffer_store_dword v5, v6, s[4:7], s58 offen sc1
    s_mov_b64 exec, -1
    s_add_u32 s74, s73, 0x1000
    s_add_u32 m0, s72, 0x1000
    s_nop 0
    buffer_load_dwordx4 v4, s[4:7], s74 offen offset:0 sc1 lds
    buffer_load_dwordx4 v4, s[4:7], s74 offen offset:1024 sc1 lds
    buffer_load_dwordx4 v4, s[4:7], s74 offen offset:2048 sc1 lds
    buffer_load_dwordx4 v4, s[4:7], s74 offen offset:3072 sc1 lds
    s_add_u32 s74, s73, 0x2000
    s_add_u32 m0, s72, 0x2000
    s_nop 0
    buffer_load_dwordx4 v4, s[4:7], s74 offen offset:0 sc1 lds
    buffer_load_dwordx4 v4, s[4:7], s74 offen offset:1024 sc1 lds
    buffer_load_dwordx4 v4, s[4:7], s74 offen offset:2048 sc1 lds
    s_add_u32 s74, s73, 0xac00
    s_add_u32 m0, s72, 0xac00
    s_nop 0
    buffer_load_dwordx4 v4, s[4:7], s74 offen offset:0 sc1 lds
    buffer_load_dwordx4 v4, s[4:7], s74 offen offset:1024 sc1 lds
    buffer_load_dwordx4 v4, s[4:7], s74 offen offset:2048 sc1 lds
    buffer_load_dwordx4 v4, s[4:7], s74 offen offset:3072 sc1 lds
    s_add_u32 s74, s73, 0xbc00
    s_add_u32 m0, s72, 0xbc00
    s_nop 0
    buffer_load_dwordx4 v4, s[4:7], s74 offen offset:0 sc1 lds
    buffer_load_dwordx4 v4, s[4:7], s74 offen offset:1024 sc1 lds
    s_cmp_eq_u32 s3, 3
    s_cbranch_scc0 L_arm_34
    s_lshl_b32 s20, s52, 12
    s_lshl_b32 s21, s53, 9
    s_add_u32 s20, s20, s21
    s_add_u32 s20, s20, 0x160000
    s_cmp_eq_u32 s34, 0
    s_cbranch_scc1 L_as_35
    s_load_dwordx8 s[24:31], s[36:37], s20
    s_branch L_arm_34
L_as_35:
    s_load_dwordx8 s[24:31], s[36:37], s20 glc
L_arm_34:
    buffer_load_dwordx4 v4, s[4:7], s74 offen offset:2048 sc1 lds
    buffer_load_dwordx4 v4, s[4:7], s74 offen offset:3072 sc1 lds
    s_add_u32 s74, s73, 0xcc00
    s_add_u32 m0, s72, 0xcc00
    s_nop 0
    buffer_load_dwordx4 v4, s[4:7], s74 offen offset:0 sc1 lds
    buffer_load_dwordx4 v4, s[4:7], s74 offen offset:1024 sc1 lds
    buffer_load_dwordx4 v4, s[4:7], s74 offen offset:2048 sc1 lds
    s_cmp_eq_u32 s3, 3
    s_cbranch_scc0 L_w3_36
    s_mov_b32 s68, s39
    s_branch L_pq_39
L_poll_37:
    s_min_u32 s21, s68, 7
    s_lshl_b32 s21, s21, 6
    s_add_u32 s21, s20, s21
    s_and_b32 s24, s34, 8
    s_cmp_lt_u32 s68, s24
    s_cbranch_scc0 L_ps_38
    s_load_dwordx8 s[24:31], s[36:37], s21
    s_branch L_pq_39
L_ps_38:
    s_load_dwordx8 s[24:31], s[36:37], s21 glc
L_pq_39:
    s_waitcnt lgkmcnt(0)
    s_xor_b32 s24, s24, s38
    s_xor_b32 s25, s25, s38
    s_xor_b32 s26, s26, s38
    s_xor_b32 s27, s27, s38
    s_xor_b32 s28, s28, s38
    s_xor_b32 s29, s29, s38
    s_xor_b32 s30, s30, s38
    s_xor_b32 s31, s31, s38
    s_or_b32 s24, s24, s25
    s_or_b32 s26, s26, s27
    s_or_b32 s28, s28, s29
    s_or_b32 s30, s30, s31
    s_or_b32 s24, s24, s26
    s_or_b32 s28, s28, s30
    s_or_b32 s24, s24, s28
    s_add_u32 s68, s68, 1
    s_cmp_eq_u32 s24, 0
    s_cbranch_scc1 L_pdone_40
    s_cmp_lt_u32 s68, 20000
    s_cbranch_scc1 L_poll_37
    s_mov_b32 s39, 20000
L_pdone_40:
    s_waitcnt lgkmcnt(0)
L_w3_36:
    s_waitcnt vmcnt(11)
    s_barrier
    ds_read_b128 v[16:19], v108 offset:0
    ds_read_b128 v[20:23], v108 offset:1024
    ds_read_b128 v[24:27], v108 offset:2048
    ds_read_b128 v[28:31], v108 offset:3072
    s_waitcnt lgkmcnt(3)
    v_mfma_f32_16x16x32_bf16 v[32:35], v[128:131], v[16:19], 0
    v_mfma_f32_16x16x32_bf16 v[36:39], v[216:219], v[16:19], 0
    s_add_u32 s74, s73, 0x15800
    s_add_u32 m0, s72, 0x15800
    s_nop 0
    buffer_load_dwordx4 v4, s[4:7], s74 offen offset:0 sc1 lds
    ds_read_b128 v[16:19], v108 offset:4096
    s_waitcnt lgkmcnt(3)
    v_mfma_f32_16x16x32_bf16 v[32:35], v[132:135], v[20:23], v[32:35]
    v_mfma_f32_16x16x32_bf16 v[36:39], v[220:223], v[20:23], v[36:39]
    ds_read_b128 v[20:23], v108 offset:5120
    s_waitcnt lgkmcnt(3)
    v_mfma_f32_16x16x32_bf16 v[32:35], v[136:139], v[24:27], v[32:35]
    v_mfma_f32_16x16x32_bf16 v[36:39], v[224:227], v[24:27], v[36:39]
    buffer_load_dwordx4 v4, s[4:7], s74 offen offset:1024 sc1 lds
    ds_read_b128 v[24:27], v108 offset:6144
    s_waitcnt lgkmcnt(3)
    v_mfma_f32_16x16x32_bf16 v[32:35], v[140:143], v[28:31], v[32:35]
    v_mfma_f32_16x16x32_bf16 v[36:39], v[228:231], v[28:31], v[36:39]
    ds_read_b128 v[28:31], v108 offset:7168
    s_waitcnt lgkmcnt(3)
    v_mfma_f32_16x16x32_bf16 v[32:35], v[144:147], v[16:19], v[32:35]
    v_mfma_f32_16x16x32_bf16 v[36:39], v[232:235], v[16:19], v[36:39]
    buffer_load_dwordx4 v4, s[4:7], s74 offen offset:2048 sc1 lds
    ds_read_b128 v[16:19], v108 offset:8192
    s_waitcnt lgkmcnt(3)
    v_mfma_f32_16x16x32_bf16 v[32:35], v[148:151], v[20:23], v[32:35]
    v_mfma_f32_16x16x32_bf16 v[36:39], v[236:239], v[20:23], v[36:39]
    ds_read_b128 v[20:23], v108 offset:9216
    s_waitcnt lgkmcnt(3)
    v_mfma_f32_16x16x32_bf16 v[32:35], v[152:155], v[24:27], v[32:35]
    v_mfma_f32_16x16x32_bf16 v[36:39], a[192:195], v[24:27], v[36:39]
    buffer_load_dwordx4 v4, s[4:7], s74 offen offset:3072 sc1 lds
    ds_read_b128 v[24:27], v108 offset:10240
    s_waitcnt lgkmcnt(3)
    v_mfma_f32_16x16x32_bf16 v[32:35], v[156:159], v[28:31], v[32:35]
    v_mfma_f32_16x16x32_bf16 v[36:39], a[196:199], v[28:31], v[36:39]
    ds_read_b128 v[28:31], v108 offset:11264
    s_waitcnt lgkmcnt(3)
    v_mfma_f32_16x16x32_bf16 v[32:35], v[160:163], v[16:19], v[32:35]
    v_mfma_f32_16x16x32_bf16 v[36:39], a[200:203], v[16:19], v[36:39]
    s_add_u32 s74, s73, 0x16800
    s_add_u32 m0, s72, 0x16800
    s_nop 0
    buffer_load_dwordx4 v4, s[4:7], s74 offen offset:0 sc1 lds
    ds_read_b128 v[16:19], v108 offset:12288
    s_waitcnt lgkmcnt(3)
    v_mfma_f32_16x16x32_bf16 v[32:35], v[164:167], v[20:23], v[32:35]
    v_mfma_f32_16x16x32_bf16 v[36:39], a[204:207], v[20:23], v[36:39]
    ds_read_b128 v[20:23], v108 offset:13312
    s_waitcnt lgkmcnt(3)
    v_mfma_f32_16x16x32_bf16 v[32:35], v[168:171], v[24:27], v[32:35]
    v_mfma_f32_16x16x32_bf16 v[36:39], a[208:211], v[24:27], v[36:39]
    buffer_load_dwordx4 v4, s[4:7], s74 offen offset:1024 sc1 lds
    ds_read_b128 v[24:27], v108 offset:14336
    s_waitcnt lgkmcnt(3)
    v_mfma_f32_16x16x32_bf16 v[32:35], v[172:175], v[28:31], v[32:35]
    v_mfma_f32_16x16x32_bf16 v[36:39], a[212:215], v[28:31], v[36:39]
    ds_read_b128 v[28:31], v108 offset:15360
    s_waitcnt lgkmcnt(3)
    v_mfma_f32_16x16x32_bf16 v[32:35], v[176:179], v[16:19], v[32:35]
    v_mfma_f32_16x16x32_bf16 v[36:39], a[216:219], v[16:19], v[36:39]
    buffer_load_dwordx4 v4, s[4:7], s74 offen offset:2048 sc1 lds
    ds_read_b128 v[16:19], v108 offset:16384
    s_waitcnt lgkmcnt(3)
    v_mfma_f32_16x16x32_bf16 v[32:35], v[180:183], v[20:23], v[32:35]
    v_mfma_f32_16x16x32_bf16 v[36:39], a[220:223], v[20:23], v[36:39]
    ds_read_b128 v[20:23], v108 offset:17408
    s_waitcnt lgkmcnt(3)
    v_mfma_f32_16x16x32_bf16 v[32:35], v[184:187], v[24:27], v[32:35]
    v_mfma_f32_16x16x32_bf16 v[36:39], a[224:227], v[24:27], v[36:39]
    buffer_load_dwordx4 v4, s[4:7], s74 offen offset:3072 sc1 lds
    ds_read_b128 v[24:27], v108 offset:18432
    s_waitcnt lgkmcnt(3)
    v_mfma_f32_16x16x32_bf16 v[32:35], v[188:191], v[28:31], v[32:35]
    v_mfma_f32_16x16x32_bf16 v[36:39], a[228:231], v[28:31], v[36:39]
    ds_read_b128 v[28:31], v108 offset:19456
    s_waitcnt lgkmcnt(3)
    v_mfma_f32_16x16x32_bf16 v[32:35], v[192:195], v[16:19], v[32:35]
    v_mfma_f32_16x16x32_bf16 v[36:39], a[232:235], v[16:19], v[36:39]
    s_add_u32 s74, s73, 0x17800
    s_add_u32 m0, s72, 0x17800
    s_nop 0
    buffer_load_dwordx4 v4, s[4:7], s74 offen offset:0 sc1 lds
    ds_read_b128 v[16:19], v108 offset:20480
    s_waitcnt lgkmcnt(3)
    v_mfma_f32_16x16x32_bf16 v[32:35], v[196:199], v[20:23], v[32:35]
    v_mfma_f32_16x16x32_bf16 v[36:39], a[236:239], v[20:23], v[36:39]
    ds_read_b128 v[20:23], v108 offset:21504
    s_waitcnt lgkmcnt(3)
    v_mfma_f32_16x16x32_bf16 v[32:35], v[200:203], v[24:27], v[32:35]
    v_mfma_f32_16x16x32_bf16 v[36:39], a[240:243], v[24:27], v[36:39]
    buffer_load_dwordx4 v4, s[4:7], s74 offen offset:1024 sc1 lds
    s_waitcnt lgkmcnt(2)
    v_mfma_f32_16x16x32_bf16 v[32:35], v[204:207], v[28:31], v[32:35]
    v_mfma_f32_16x16x32_bf16 v[36:39], a[244:247], v[28:31], v[36:39]
    s_waitcnt lgkmcnt(1)
    v_mfma_f32_16x16x32_bf16 v[32:35], v[208:211], v[16:19], v[32:35]
    v_mfma_f32_16x16x32_bf16 v[36:39], a[248:251], v[16:19], v[36:39]
    buffer_load_dwordx4 v4, s[4:7], s74 offen offset:2048 sc1 lds
    s_waitcnt lgkmcnt(0)
    s_cmp_eq_u32 s54, 1
    s_cbranch_scc1 L_skip_41
    v_mfma_f32_16x16x32_bf16 v[32:35], v[212:215], v[20:23], v[32:35]
    v_mfma_f32_16x16x32_bf16 v[36:39], a[252:255], v[20:23], v[36:39]
    s_nop 7
L_skip_41:
    s_waitcnt vmcnt(11)
    s_barrier
    ds_read_b128 v[16:19], v109 offset:0
    ds_read_b128 v[20:23], v109 offset:1024
    ds_read_b128 v[24:27], v109 offset:2048
    ds_read_b128 v[28:31], v109 offset:3072
    s_waitcnt lgkmcnt(3)
    v_mfma_f32_16x16x32_bf16 v[40:43], v[128:131], v[16:19], 0
    v_mfma_f32_16x16x32_bf16 v[44:47], v[216:219], v[16:19], 0
    s_add_u32 s74, s73, 0x20400
    s_add_u32 m0, s72, 0x0
    s_nop 0
    buffer_load_dwordx4 v4, s[4:7], s74 offen offset:0 sc1 lds
    ds_read_b128 v[16:19], v109 offset:4096
    s_waitcnt lgkmcnt(3)
    v_mfma_f32_16x16x32_bf16 v[40:43], v[132:135], v[20:23], v[40:43]
    v_mfma_f32_16x16x32_bf16 v[44:47], v[220:223], v[20:23], v[44:47]
    ds_read_b128 v[20:23], v109 offset:5120
    s_waitcnt lgkmcnt(3)
    v_mfma_f32_16x16x32_bf16 v[40:43], v[136:139], v[24:27], v[40:43]
    v_mfma_f32_16x16x32_bf16 v[44:47], v[224:227], v[24:27], v[44:47]
    buffer_load_dwordx4 v4, s[4:7], s74 offen offset:1024 sc1 lds
    ds_read_b128 v[24:27], v109 offset:6144
    s_waitcnt lgkmcnt(3)
    v_mfma_f32_16x16x32_bf16 v[40:43], v[140:143], v[28:31], v[40:43]
    v_mfma_f32_16x16x32_bf16 v[44:47], v[228:231], v[28:31], v[44:47]
    ds_read_b128 v[28:31], v109 offset:7168
    s_waitcnt lgkmcnt(3)
    v_mfma_f32_16x16x32_bf16 v[40:43], v[144:147], v[16:19], v[40:43]
    v_mfma_f32_16x16x32_bf16 v[44:47], v[232:235], v[16:19], v[44:47]
    buffer_load_dwordx4 v4, s[4:7], s74 offen offset:2048 sc1 lds
    ds_read_b128 v[16:19], v109 offset:8192
    s_waitcnt lgkmcnt(3)
    v_mfma_f32_16x16x32_bf16 v[40:43], v[148:151], v[20:23], v[40:43]
    v_mfma_f32_16x16x32_bf16 v[44:47], v[236:239], v[20:23], v[44:47]
    ds_read_b128 v[20:23], v109 offset:9216
    s_waitcnt lgkmcnt(3)
    v_mfma_f32_16x16x32_bf16 v[40:43], v[152:155], v[24:27], v[40:43]
    v_mfma_f32_16x16x32_bf16 v[44:47], a[192:195], v[24:27], v[44:47]
    buffer_load_dwordx4 v4, s[4:7], s74 offen offset:3072 sc1 lds
    ds_read_b128 v[24:27], v109 offset:10240
    s_waitcnt lgkmcnt(3)
    v_mfma_f32_16x16x32_bf16 v[40:43], v[156:159], v[28:31], v[40:43]
    v_mfma_f32_16x16x32_bf16 v[44:47], a[196:199], v[28:31], v[44:47]
    ds_read_b128 v[28:31], v109 offset:11264
    s_waitcnt lgkmcnt(3)
    v_mfma_f32_16x16x32_bf16 v[40:43], v[160:163], v[16:19], v[40:43]
    v_mfma_f32_16x16x32_bf16 v[44:47], a[200:203], v[16:19], v[44:47]
    s_add_u32 s74, s73, 0x21400
    s_add_u32 m0, s72, 0x1000
    s_nop 0
    buffer_load_dwordx4 v4, s[4:7], s74 offen offset:0 sc1 lds
    ds_read_b128 v[16:19], v109 offset:12288
    s_waitcnt lgkmcnt(3)
    v_mfma_f32_16x16x32_bf16 v[40:43], v[164:167], v[20:23], v[40:43]
    v_mfma_f32_16x16x32_bf16 v[44:47], a[204:207], v[20:23], v[44:47]
    ds_read_b128 v[20:23], v109 offset:13312
    s_waitcnt lgkmcnt(3)
    v_mfma_f32_16x16x32_bf16 v[40:43], v[168:171], v[24:27], v[40:43]
    v_mfma_f32_16x16x32_bf16 v[44:47], a[208:211], v[24:27], v[44:47]
    buffer_load_dwordx4 v4, s[4:7], s74 offen offset:1024 sc1 lds
    ds_read_b128 v[24:27], v109 offset:14336
    s_waitcnt lgkmcnt(3)
    v_mfma_f32_16x16x32_bf16 v[40:43], v[172:175], v[28:31], v[40:43]
    v_mfma_f32_16x16x32_bf16 v[44:47], a[212:215], v[28:31], v[44:47]
    ds_read_b128 v[28:31], v109 offset:15360
    s_waitcnt lgkmcnt(3)
    v_mfma_f32_16x16x32_bf16 v[40:43], v[176:179], v[16:19], v[40:43]
    v_mfma_f32_16x16x32_bf16 v[44:47], a[216:219], v[16:19], v[44:47]
    buffer_load_dwordx4 v4, s[4:7], s74 offen offset:2048 sc1 lds
    ds_read_b128 v[16:19], v109 offset:16384
    s_waitcnt lgkmcnt(3)
    v_mfma_f32_16x16x32_bf16 v[40:43], v[180:183], v[20:23], v[40:43]
    v_mfma_f32_16x16x32_bf16 v[44:47], a[220:223], v[20:23], v[44:47]
    ds_read_b128 v[20:23], v109 offset:17408
    s_waitcnt lgkmcnt(3)
    v_mfma_f32_16x16x32_bf16 v[40:43], v[184:187], v[24:27], v[40:43]
    v_mfma_f32_16x16x32_bf16 v[44:47], a[224:227], v[24:27], v[44:47]
    buffer_load_dwordx4 v4, s[4:7], s74 offen offset:3072 sc1 lds
    ds_read_b128 v[24:27], v109 offset:18432
    s_waitcnt lgkmcnt(3)
    v_mfma_f32_16x16x32_bf16 v[40:43], v[188:191], v[28:31], v[40:43]
    v_mfma_f32_16x16x32_bf16 v[44:47], a[228:231], v[28:31], v[44:47]
    ds_read_b128 v[28:31], v109 offset:19456
    s_waitcnt lgkmcnt(3)
    v_mfma_f32_16x16x32_bf16 v[40:43], v[192:195], v[16:19], v[40:43]
    v_mfma_f32_16x16x32_bf16 v[44:47], a[232:235], v[16:19], v[44:47]
    s_add_u32 s74, s73, 0x22400
    s_add_u32 m0, s72, 0x2000
    s_nop 0
    buffer_load_dwordx4 v4, s[4:7], s74 offen offset:0 sc1 lds
    ds_read_b128 v[16:19], v109 offset:20480
    s_waitcnt lgkmcnt(3)
    v_mfma_f32_16x16x32_bf16 v[40:43], v[196:199], v[20:23], v[40:43]
    v_mfma_f32_16x16x32_bf16 v[44:47], a[236:239], v[20:23], v[44:47]
    ds_read_b128 v[20:23], v109 offset:21504
    s_waitcnt lgkmcnt(3)
    v_mfma_f32_16x16x32_bf16 v[40:43], v[200:203], v[24:27], v[40:43]
    v_mfma_f32_16x16x32_bf16 v[44:47], a[240:243], v[24:27], v[44:47]
    buffer_load_dwordx4 v4, s[4:7], s74 offen offset:1024 sc1 lds
    s_waitcnt lgkmcnt(2)
    v_mfma_f32_16x16x32_bf16 v[40:43], v[204:207], v[28:31], v[40:43]
    v_mfma_f32_16x16x32_bf16 v[44:47], a[244:247], v[28:31], v[44:47]
    s_waitcnt lgkmcnt(1)
    v_mfma_f32_16x16x32_bf16 v[40:43], v[208:211], v[16:19], v[40:43]
    v_mfma_f32_16x16x32_bf16 v[44:47], a[248:251], v[16:19], v[44:47]
    buffer_load_dwordx4 v4, s[4:7], s74 offen offset:2048 sc1 lds
    s_waitcnt lgkmcnt(0)
    s_cmp_eq_u32 s54, 1
    s_cbranch_scc1 L_skip_42
    v_mfma_f32_16x16x32_bf16 v[40:43], v[212:215], v[20:23], v[40:43]
    v_mfma_f32_16x16x32_bf16 v[44:47], a[252:255], v[20:23], v[44:47]
    s_nop 7
L_skip_42:
    s_waitcnt vmcnt(11)
    s_barrier
    ds_read_b128 v[16:19], v110 offset:0
    ds_read_b128 v[20:23], v110 offset:1024
    ds_read_b128 v[24:27], v110 offset:2048
    ds_read_b128 v[28:31], v110 offset:3072
    s_waitcnt lgkmcnt(3)
    v_mfma_f32_16x16x32_bf16 v[48:51], v[128:131], v[16:19], 0
    v_mfma_f32_16x16x32_bf16 v[52:55], v[216:219], v[16:19], 0
    ds_read_b128 v[16:19], v110 offset:4096
    s_waitcnt lgkmcnt(3)
    v_mfma_f32_16x16x32_bf16 v[48:51], v[132:135], v[20:23], v[48:51]
    v_mfma_f32_16x16x32_bf16 v[52:55], v[220:223], v[20:23], v[52:55]
    ds_read_b128 v[20:23], v110 offset:5120
    s_waitcnt lgkmcnt(3)
    v_mfma_f32_16x16x32_bf16 v[48:51], v[136:139], v[24:27], v[48:51]
    v_mfma_f32_16x16x32_bf16 v[52:55], v[224:227], v[24:27], v[52:55]
    ds_read_b128 v[24:27], v110 offset:6144
    s_waitcnt lgkmcnt(3)
    v_mfma_f32_16x16x32_bf16 v[48:51], v[140:143], v[28:31], v[48:51]
    v_mfma_f32_16x16x32_bf16 v[52:55], v[228:231], v[28:31], v[52:55]
    ds_read_b128 v[28:31], v110 offset:7168
    s_waitcnt lgkmcnt(3)
    v_mfma_f32_16x16x32_bf16 v[48:51], v[144:147], v[16:19], v[48:51]
    v_mfma_f32_16x16x32_bf16 v[52:55], v[232:235], v[16:19], v[52:55]
    ds_read_b128 v[16:19], v110 offset:8192
    s_waitcnt lgkmcnt(3)
    v_mfma_f32_16x16x32_bf16 v[48:51], v[148:151], v[20:23], v[48:51]
    v_mfma_f32_16x16x32_bf16 v[52:55], v[236:239], v[20:23], v[52:55]
    ds_read_b128 v[20:23], v110 offset:9216
    s_waitcnt lgkmcnt(3)
    v_mfma_f32_16x16x32_bf16 v[48:51], v[152:155], v[24:27], v[48:51]
    v_mfma_f32_16x16x32_bf16 v[52:55], a[192:195], v[24:27], v[52:55]
    ds_read_b128 v[24:27], v110 offset:10240
    s_waitcnt lgkmcnt(3)
    v_mfma_f32_16x16x32_bf16 v[48:51], v[156:159], v[28:31], v[48:51]
    v_mfma_f32_16x16x32_bf16 v[52:55], a[196:199], v[28:31], v[52:55]
    ds_read_b128 v[28:31], v110 offset:11264
    s_waitcnt lgkmcnt(3)
    v_mfma_f32_16x16x32_bf16 v[48:51], v[160:163], v[16:19], v[48:51]
    v_mfma_f32_16x16x32_bf16 v[52:55], a[200:203], v[16:19], v[52:55]
    ds_read_b128 v[16:19], v110 offset:12288
    s_waitcnt lgkmcnt(3)
    v_mfma_f32_16x16x32_bf16 v[48:51], v[164:167], v[20:23], v[48:51]
    v_mfma_f32_16x16x32_bf16 v[52:55], a[204:207], v[20:23], v[52:55]
    ds_read_b128 v[20:23], v110 offset:13312
    s_waitcnt lgkmcnt(3)
    v_mfma_f32_16x16x32_bf16 v[48:51], v[168:171], v[24:27], v[48:51]
    v_mfma_f32_16x16x32_bf16 v[52:55], a[208:211], v[24:27], v[52:55]
    ds_read_b128 v[24:27], v110 offset:14336
    s_waitcnt lgkmcnt(3)
    v_mfma_f32_16x16x32_bf16 v[48:51], v[172:175], v[28:31], v[48:51]
    v_mfma_f32_16x16x32_bf16 v[52:55], a[212:215], v[28:31], v[52:55]
    ds_read_b128 v[28:31], v110 offset:15360
    s_waitcnt lgkmcnt(3)
    v_mfma_f32_16x16x32_bf16 v[48:51], v[176:179], v[16:19], v[48:51]
    v_mfma_f32_16x16x32_bf16 v[52:55], a[216:219], v[16:19], v[52:55]
    ds_read_b128 v[16:19], v110 offset:16384
    s_waitcnt lgkmcnt(3)
    v_mfma_f32_16x16x32_bf16 v[48:51], v[180:183], v[20:23], v[48:51]
    v_mfma_f32_16x16x32_bf16 v[52:55], a[220:223], v[20:23], v[52:55]
    ds_read_b128 v[20:23], v110 offset:17408
    s_waitcnt lgkmcnt(3)
    v_mfma_f32_16x16x32_bf16 v[48:51], v[184:187], v[24:27], v[48:51]
    v_mfma_f32_16x16x32_bf16 v[52:55], a[224:227], v[24:27], v[52:55]
    ds_read_b128 v[24:27], v110 offset:18432
    s_waitcnt lgkmcnt(3)
    v_mfma_f32_16x16x32_bf16 v[48:51], v[188:191], v[28:31], v[48:51]
    v_mfma_f32_16x16x32_bf16 v[52:55], a[228:231], v[28:31], v[52:55]
    ds_read_b128 v[28:31], v110 offset:19456
    s_waitcnt lgkmcnt(3)
    v_mfma_f32_16x16x32_bf16 v[48:51], v[192:195], v[16:19], v[48:51]
    v_mfma_f32_16x16x32_bf16 v[52:55], a[232:235], v[16:19], v[52:55]
    ds_read_b128 v[16:19], v110 offset:20480
    s_waitcnt lgkmcnt(3)
    v_mfma_f32_16x16x32_bf16 v[48:51], v[196:199], v[20:23], v[48:51]
    v_mfma_f32_16x16x32_bf16 v[52:55], a[236:239], v[20:23], v[52:55]
    ds_read_b128 v[20:23], v110 offset:21504
    s_waitcnt lgkmcnt(3)
    v_mfma_f32_16x16x32_bf16 v[48:51], v[200:203], v[24:27], v[48:51]
    v_mfma_f32_16x16x32_bf16 v[52:55], a[240:243], v[24:27], v[52:55]
    s_waitcnt lgkmcnt(2)
    v_mfma_f32_16x16x32_bf16 v[48:51], v[204:207], v[28:31], v[48:51]
    v_mfma_f32_16x16x32_bf16 v[52:55], a[244:247], v[28:31], v[52:55]
    s_waitcnt lgkmcnt(1)
    v_mfma_f32_16x16x32_bf16 v[48:51], v[208:211], v[16:19], v[48:51]
    v_mfma_f32_16x16x32_bf16 v[52:55], a[248:251], v[16:19], v[52:55]
    s_waitcnt lgkmcnt(0)
    s_cmp_eq_u32 s54, 1
    s_cbranch_scc1 L_skip_43
    v_mfma_f32_16x16x32_bf16 v[48:51], v[212:215], v[20:23], v[48:51]
    v_mfma_f32_16x16x32_bf16 v[52:55], a[252:255], v[20:23], v[52:55]
    s_nop 7
L_skip_43:
    s_waitcnt vmcnt(0)
    s_barrier
    ds_read_b128 v[16:19], v108 offset:0
    ds_read_b128 v[20:23], v108 offset:1024
    ds_read_b128 v[24:27], v108 offset:2048
    ds_read_b128 v[28:31], v108 offset:3072
    s_waitcnt lgkmcnt(3)
    v_mfma_f32_16x16x32_bf16 v[56:59], v[128:131], v[16:19], 0
    v_mfma_f32_16x16x32_bf16 v[60:63], v[216:219], v[16:19], 0
    ds_read_b128 v[16:19], v108 offset:4096
    s_waitcnt lgkmcnt(3)
    v_mfma_f32_16x16x32_bf16 v[56:59], v[132:135], v[20:23], v[56:59]
    v_mfma_f32_16x16x32_bf16 v[60:63], v[220:223], v[20:23], v[60:63]
    ds_read_b128 v[20:23], v108 offset:5120
    s_waitcnt lgkmcnt(3)
    v_mfma_f32_16x16x32_bf16 v[56:59], v[136:139], v[24:27], v[56:59]
    v_mfma_f32_16x16x32_bf16 v[60:63], v[224:227], v[24:27], v[60:63]
    ds_read_b128 v[24:27], v108 offset:6144
    s_waitcnt lgkmcnt(3)
    v_mfma_f32_16x16x32_bf16 v[56:59], v[140:143], v[28:31], v[56:59]
    v_mfma_f32_16x16x32_bf16 v[60:63], v[228:231], v[28:31], v[60:63]
    ds_read_b128 v[28:31], v108 offset:7168
    s_waitcnt lgkmcnt(3)
    v_mfma_f32_16x16x32_bf16 v[56:59], v[144:147], v[16:19], v[56:59]
    v_mfma_f32_16x16x32_bf16 v[60:63], v[232:235], v[16:19], v[60:63]
    ds_read_b128 v[16:19], v108 offset:8192
    s_waitcnt lgkmcnt(3)
    v_mfma_f32_16x16x32_bf16 v[56:59], v[148:151], v[20:23], v[56:59]
    v_mfma_f32_16x16x32_bf16 v[60:63], v[236:239], v[20:23], v[60:63]
    ds_read_b128 v[20:23], v108 offset:9216
    s_waitcnt lgkmcnt(3)
    v_mfma_f32_16x16x32_bf16 v[56:59], v[152:155], v[24:27], v[56:59]
    v_mfma_f32_16x16x32_bf16 v[60:63], a[192:195], v[24:27], v[60:63]
    ds_read_b128 v[24:27], v108 offset:10240
    s_waitcnt lgkmcnt(3)
    v_mfma_f32_16x16x32_bf16 v[56:59], v[156:159], v[28:31], v[56:59]
    v_mfma_f32_16x16x32_bf16 v[60:63], a[196:199], v[28:31], v[60:63]
    ds_read_b128 v[28:31], v108 offset:11264
    s_waitcnt lgkmcnt(3)
    v_mfma_f32_16x16x32_bf16 v[56:59], v[160:163], v[16:19], v[56:59]
    v_mfma_f32_16x16x32_bf16 v[60:63], a[200:203], v[16:19], v[60:63]
    ds_read_b128 v[16:19], v108 offset:12288
    s_waitcnt lgkmcnt(3)
    v_mfma_f32_16x16x32_bf16 v[56:59], v[164:167], v[20:23], v[56:59]
    v_mfma_f32_16x16x32_bf16 v[60:63], a[204:207], v[20:23], v[60:63]
    ds_read_b128 v[20:23], v108 offset:13312
    s_waitcnt lgkmcnt(3)
    v_mfma_f32_16x16x32_bf16 v[56:59], v[168:171], v[24:27], v[56:59]
    v_mfma_f32_16x16x32_bf16 v[60:63], a[208:211], v[24:27], v[60:63]
    ds_read_b128 v[24:27], v108 offset:14336
    s_waitcnt lgkmcnt(3)
    v_mfma_f32_16x16x32_bf16 v[56:59], v[172:175], v[28:31], v[56:59]
    v_mfma_f32_16x16x32_bf16 v[60:63], a[212:215], v[28:31], v[60:63]
    ds_read_b128 v[28:31], v108 offset:15360
    s_waitcnt lgkmcnt(3)
    v_mfma_f32_16x16x32_bf16 v[56:59], v[176:179], v[16:19], v[56:59]
    v_mfma_f32_16x16x32_bf16 v[60:63], a[216:219], v[16:19], v[60:63]
    ds_read_b128 v[16:19], v108 offset:16384
    s_waitcnt lgkmcnt(3)
    v_mfma_f32_16x16x32_bf16 v[56:59], v[180:183], v[20:23], v[56:59]
    v_mfma_f32_16x16x32_bf16 v[60:63], a[220:223], v[20:23], v[60:63]
    ds_read_b128 v[20:23], v108 offset:17408
    s_waitcnt lgkmcnt(3)
    v_mfma_f32_16x16x32_bf16 v[56:59], v[184:187], v[24:27], v[56:59]
    v_mfma_f32_16x16x32_bf16 v[60:63], a[224:227], v[24:27], v[60:63]
    ds_read_b128 v[24:27], v108 offset:18432
    s_waitcnt lgkmcnt(3)
    v_mfma_f32_16x16x32_bf16 v[56:59], v[188:191], v[28:31], v[56:59]
    v_mfma_f32_16x16x32_bf16 v[60:63], a[228:231], v[28:31], v[60:63]
    ds_read_b128 v[28:31], v108 offset:19456
    s_waitcnt lgkmcnt(3)
    v_mfma_f32_16x16x32_bf16 v[56:59], v[192:195], v[16:19], v[56:59]
    v_mfma_f32_16x16x32_bf16 v[60:63], a[232:235], v[16:19], v[60:63]
    ds_read_b128 v[16:19], v108 offset:20480
    s_waitcnt lgkmcnt(3)
    v_mfma_f32_16x16x32_bf16 v[56:59], v[196:199], v[20:23], v[56:59]
    v_mfma_f32_16x16x32_bf16 v[60:63], a[236:239], v[20:23], v[60:63]
    ds_read_b128 v[20:23], v108 offset:21504
    s_waitcnt lgkmcnt(3)
    v_mfma_f32_16x16x32_bf16 v[56:59], v[200:203], v[24:27], v[56:59]
    v_mfma_f32_16x16x32_bf16 v[60:63], a[240:243], v[24:27], v[60:63]
    s_waitcnt lgkmcnt(2)
    v_mfma_f32_16x16x32_bf16 v[56:59], v[204:207], v[28:31], v[56:59]
    v_mfma_f32_16x16x32_bf16 v[60:63], a[244:247], v[28:31], v[60:63]
    s_waitcnt lgkmcnt(1)
    v_mfma_f32_16x16x32_bf16 v[56:59], v[208:211], v[16:19], v[56:59]
    v_mfma_f32_16x16x32_bf16 v[60:63], a[248:251], v[16:19], v[60:63]
    s_waitcnt lgkmcnt(0)
    s_cmp_eq_u32 s54, 1
    s_cbranch_scc1 L_skip_44
    v_mfma_f32_16x16x32_bf16 v[56:59], v[212:215], v[20:23], v[56:59]
    v_mfma_f32_16x16x32_bf16 v[60:63], a[252:255], v[20:23], v[60:63]
    s_nop 7
L_skip_44:
    v_cndmask_b32 v80, v40, v32, s[56:57]
    v_cndmask_b32 v81, v41, v33, s[56:57]
    v_cndmask_b32 v82, v42, v34, s[56:57]
    v_cndmask_b32 v83, v43, v35, s[56:57]
    v_cndmask_b32 v84, v44, v36, s[56:57]
    v_cndmask_b32 v85, v45, v37, s[56:57]
    v_cndmask_b32 v86, v46, v38, s[56:57]
    v_cndmask_b32 v87, v47, v39, s[56:57]
    v_cndmask_b32 v88, v56, v48, s[56:57]
    v_cndmask_b32 v89, v57, v49, s[56:57]
    v_cndmask_b32 v90, v58, v50, s[56:57]
    v_cndmask_b32 v91, v59, v51, s[56:57]
    v_cndmask_b32 v92, v60, v52, s[56:57]
    v_cndmask_b32 v93, v61, v53, s[56:57]
    v_cndmask_b32 v94, v62, v54, s[56:57]
    v_cndmask_b32 v95, v63, v55, s[56:57]
    s_lshl_b32 s58, s3, 12
    s_add_u32 s58, s58, 132096
    v_add_u32 v5, s58, v4
    s_lshl_b32 s58, s3, 12
    s_xor_b32 s58, s58, 8192
    s_add_u32 s58, s58, 132096
    v_add_u32 v6, s58, v4
    ds_write_b128 v5, v[80:83] offset:0
    ds_write_b128 v5, v[84:87] offset:1024
    ds_write_b128 v5, v[88:91] offset:2048
    ds_write_b128 v5, v[92:95] offset:3072
    v_cndmask_b32 v64, v32, v40, s[56:57]
    v_cndmask_b32 v65, v33, v41, s[56:57]
    v_cndmask_b32 v66, v34, v42, s[56:57]
    v_cndmask_b32 v67, v35, v43, s[56:57]
    v_cndmask_b32 v68, v36, v44, s[56:57]
    v_cndmask_b32 v69, v37, v45, s[56:57]
    v_cndmask_b32 v70, v38, v46, s[56:57]
    v_cndmask_b32 v71, v39, v47, s[56:57]
    v_cndmask_b32 v72, v48, v56, s[56:57]
    v_cndmask_b32 v73, v49, v57, s[56:57]
    v_cndmask_b32 v74, v50, v58, s[56:57]
    v_cndmask_b32 v75, v51, v59, s[56:57]
    v_cndmask_b32 v76, v52, v60, s[56:57]
    v_cndmask_b32 v77, v53, v61, s[56:57]
    v_cndmask_b32 v78, v54, v62, s[56:57]
    v_cndmask_b32 v79, v55, v63, s[56:57]
    s_waitcnt lgkmcnt(0)
    s_barrier
    ds_read_b128 v[32:35], v6 offset:0
    ds_read_b128 v[36:39], v6 offset:1024
    ds_read_b128 v[40:43], v6 offset:2048
    ds_read_b128 v[44:47], v6 offset:3072
    s_waitcnt lgkmcnt(3)
    v_pk_add_f32 v[64:65], v[64:65], v[32:33]
    v_pk_add_f32 v[66:67], v[66:67], v[34:35]
    s_waitcnt lgkmcnt(2)
    v_pk_add_f32 v[68:69], v[68:69], v[36:37]
    v_pk_add_f32 v[70:71], v[70:71], v[38:39]
    s_waitcnt lgkmcnt(1)
    v_pk_add_f32 v[72:73], v[72:73], v[40:41]
    v_pk_add_f32 v[74:75], v[74:75], v[42:43]
    s_waitcnt lgkmcnt(0)
    v_pk_add_f32 v[76:77], v[76:77], v[44:45]
    v_pk_add_f32 v[78:79], v[78:79], v[46:47]
    v_lshlrev_b32 v116, 10, v2
    v_lshl_add_u32 v116, v3, 4, v116
    s_lshl_b32 s58, s52, 2
    s_add_u32 s58, s58, s54
    s_lshl_b32 s58, s58, 14
    s_lshl_b32 s59, s53, 7
    s_add_u32 s58, s58, s59
    s_lshl_b32 s59, s55, 6
    s_add_u32 s58, s58, s59
    s_add_u32 s59, s58, 32768
    v_lshlrev_b32 v32, 16, v8
    v_and_b32 v33, 0xffff0000, v8
    v_lshlrev_b32 v34, 16, v9
    v_and_b32 v35, 0xffff0000, v9
    v_lshlrev_b32 v36, 16, v10
    v_and_b32 v37, 0xffff0000, v10
    v_lshlrev_b32 v38, 16, v11
    v_and_b32 v39, 0xffff0000, v11
    v_pk_fma_f32 v[32:33], v[240:241], v[64:65], v[32:33]
    v_pk_fma_f32 v[34:35], v[242:243], v[66:67], v[34:35]
    v_pk_fma_f32 v[36:37], v[244:245], v[68:69], v[36:37]
    v_pk_fma_f32 v[38:39], v[246:247], v[70:71], v[38:39]
    v_cvt_pk_bf16_f32 v48, v32, v33
    v_cvt_pk_bf16_f32 v49, v34, v35
    v_cvt_pk_bf16_f32 v50, v36, v37
    v_cvt_pk_bf16_f32 v51, v38, v39
    buffer_store_dwordx4 v[48:51], v116, s[12:15], s58 offen sc1
    v_lshlrev_b32 v40, 16, v12
    v_and_b32 v41, 0xffff0000, v12
    v_lshlrev_b32 v42, 16, v13
    v_and_b32 v43, 0xffff0000, v13
    v_lshlrev_b32 v44, 16, v14
    v_and_b32 v45, 0xffff0000, v14
    v_lshlrev_b32 v46, 16, v15
    v_and_b32 v47, 0xffff0000, v15
    v_pk_fma_f32 v[40:41], v[240:241], v[72:73], v[40:41]
    v_pk_fma_f32 v[42:43], v[242:243], v[74:75], v[42:43]
    v_pk_fma_f32 v[44:45], v[244:245], v[76:77], v[44:45]
    v_pk_fma_f32 v[46:47], v[246:247], v[78:79], v[46:47]
    v_cvt_pk_bf16_f32 v52, v40, v41
    v_cvt_pk_bf16_f32 v53, v42, v43
    v_cvt_pk_bf16_f32 v54, v44, v45
    v_cvt_pk_bf16_f32 v55, v46, v47
    buffer_store_dwordx4 v[52:55], v116, s[12:15], s59 offen sc1
    s_nop 1
L_fin:
    s_waitcnt vmcnt(0)
    s_or_b32 s58, s2, s3
    s_cmp_eq_u32 s58, 0
    s_cselect_b64 exec, 1, 0
    v_mov_b32 v5, 0
    v_mov_b32 v6, s38
    buffer_store_dword v6, v5, s[4:7], 0 offen offset:0 sc1
    s_nop 1
L_end:
    s_endpgm
L_code_end:

.section .rodata,"a"
.p2align 6
.amdhsa_kernel adaLN_cond__sliding_local_dilated__dense_activation_silu__prompt_kernel
  .amdhsa_next_free_vgpr 512
  .amdhsa_next_free_sgpr 102
  .amdhsa_accum_offset 256
  .amdhsa_group_segment_fixed_size 0
  .amdhsa_kernarg_size 88
  .amdhsa_user_sgpr_count 2
  .amdhsa_user_sgpr_kernarg_segment_ptr 1
  .amdhsa_system_sgpr_workgroup_id_x 1
.end_amdhsa_kernel
```
